```python
import torch

def _softmax(x, axis=-1):
    return torch.softmax(x, dim=axis)
def _gelu(x):
    return torch.nn.functional.gelu(x, approximate="tanh")
def _silu(x):
    return torch.nn.functional.silu(x)
def _sigmoid(x):
    return torch.sigmoid(x)
def _layernorm(x, axis=-1, eps=1e-5):
    m = x.mean(dim=axis, keepdim=True)
    v = x.var(dim=axis, keepdim=True, unbiased=False)
    return (x - m) / torch.sqrt(v + eps)
def _scatter_add(tgt, idx, src, axis=0):
    return tgt.clone().index_add_(axis, idx, src)
def _segment_sum(src, seg, n):
    out = torch.zeros((n,) + src.shape[1:], dtype=src.dtype)
    return out.index_add_(0, seg, src)
def _pad(x, pw):
    flat = tuple(v for pair in reversed(pw) for v in pair)
    return torch.nn.functional.pad(x, flat)

kernel_name = 'recurrent_scan__mha_block_cached__glu_gated_reglu__decode'

def setup_inputs():

    _w = (lambda a: (lambda t: t.to(torch.bfloat16) if t.is_floating_point() else t)(torch.as_tensor(a)))
    def _A_setup():
        B, Sq, D = 1, 1, 640
        H, Sk, Dh = 32, 32768, 192
        return {
            "x": _w((lambda *s: torch.randn(*s, dtype=torch.bfloat16) * 0.4)(B, Sq, D)),
            "k_cache": _w((lambda *s: torch.randn(*s, dtype=torch.bfloat16) * 1.6)(B, H, Sk, Dh)),
            "v_cache": _w((lambda *s: torch.randn(*s, dtype=torch.bfloat16) * 1.6)(B, H, Sk, Dh)),
            "wq": _w((lambda *s: torch.randn(*s, dtype=torch.bfloat16) * 1.6)(D, H * Dh) * (D ** -0.5)),
            "wo": _w((lambda *s: torch.randn(*s, dtype=torch.bfloat16) * 1.6)(H * Dh, D) * ((H * Dh) ** -0.5)),
        }
    _A_in = _A_setup()

    def _B_setup():
        B, S, D, F = 1, 1, 640, 1536
        return {
            "x": _w((lambda *s: torch.randn(*s, dtype=torch.bfloat16) * 0.4)(B, S, D)),
            "W_gate": _w((lambda *s: torch.randn(*s, dtype=torch.bfloat16) * 1.6)(D, F) * (2.0 / D) ** 0.5),
            "W_up": _w((lambda *s: torch.randn(*s, dtype=torch.bfloat16) * 1.6)(D, F) * (2.0 / D) ** 0.5),
            "W_down": _w((lambda *s: torch.randn(*s, dtype=torch.bfloat16) * 1.6)(F, D) * (1.0 / F) ** 0.5),
        }
    _B_in = _B_setup()

    return {
        "A_x": _A_in["x"],
        "A_k_cache": _A_in["k_cache"],
        "A_v_cache": _A_in["v_cache"],
        "A_wq": _A_in["wq"],
        "A_wo": _A_in["wo"],
        "B_x": _B_in["x"],
        "B_W_gate": _B_in["W_gate"],
        "B_W_up": _B_in["W_up"],
        "B_W_down": _B_in["W_down"],
    }

def reference(A_x, A_k_cache, A_v_cache, A_wq, A_wo, B_x, B_W_gate, B_W_up, B_W_down):
    def _A_ref(x, k_cache, v_cache, wq, wo):
        B, Sq, D = x.shape
        H, Dh = 32, 192
        q = (lambda x, *d: x.permute(*d))((x @ wq).reshape(B, Sq, H, Dh), 0, 2, 1, 3)
        scores = torch.einsum("bhqd,bhkd->bhqk", q, k_cache) * (Dh ** -0.5)
        p = _softmax(scores, axis=-1)
        o = torch.einsum("bhqk,bhkd->bhqd", p, v_cache)
        return (lambda x, *d: x.permute(*d))(o, 0, 2, 1, 3).reshape(B, Sq, H * Dh) @ wo

    def _B_ref(x, W_gate, W_up, W_down):
        gate = torch.einsum("bsd,df->bsf", x, W_gate)
        up = torch.einsum("bsd,df->bsf", x, W_up)
        gate = gate * (lambda x, dt: x.to(dt))(gate > 0, gate.dtype)
        h = gate * up
        return torch.einsum("bsf,fd->bsd", h, W_down)

    x = A_x
    xn = _layernorm(x, axis=-1)
    s = _A_ref(xn, A_k_cache, A_v_cache, A_wq, A_wo)
    g = _silu(_B_ref(xn, B_W_gate, B_W_up, B_W_down))
    return x + s * g
```

```asm
; @launch grid=(256,1,1) block=(192,1,1) lds=163840
.amdgcn_target "amdgcn-amd-amdhsa--gfx950"
.text
.globl recurrent_scan__mha_block_cached__glu_gated_reglu__decode_kernel
.p2align 8
.type recurrent_scan__mha_block_cached__glu_gated_reglu__decode_kernel,@function
recurrent_scan__mha_block_cached__glu_gated_reglu__decode_kernel:
s_cmp_ge_u32 s2, 256
s_cbranch_scc1 L_exit
s_load_dwordx16 s[40:55], s[0:1], 0
s_load_dwordx8 s[56:63], s[0:1], 64
v_lshrrev_b32 v1, 6, v0
v_and_b32 v0, 63, v0
v_readfirstlane_b32 s3, v1
s_lshr_b32 s4, s2, 3
s_and_b32 s5, s2, 7
v_and_b32 v6, 1, v0
v_lshlrev_b32 v6, 4, v6
v_mov_b32 v7, 0xffff
v_lshlrev_b32 v7, v6, v7
v_bfe_u32 v6, v0, 1, 2
v_cmp_eq_u32 vcc, 0, v6
s_nop 1
v_cndmask_b32 v20, 0, v7, vcc
v_cmp_eq_u32 vcc, 1, v6
s_nop 1
v_cndmask_b32 v21, 0, v7, vcc
v_cmp_eq_u32 vcc, 2, v6
s_nop 1
v_cndmask_b32 v22, 0, v7, vcc
v_cmp_eq_u32 vcc, 3, v6
s_nop 1
v_cndmask_b32 v23, 0, v7, vcc
v_lshrrev_b32 v6, 3, v0
v_and_b32 v7, 7, v0
s_waitcnt lgkmcnt(0)
s_mov_b32 s16, s62
s_and_b32 s17, s63, 0xffff
s_mov_b32 s18, 4194304
s_mov_b32 s19, 0x20000
s_cmp_eq_u32 s3, 2
s_cbranch_scc1 L_helper
s_mov_b32 s8, s42
s_and_b32 s9, s43, 0xffff
s_mov_b32 s10, 402653184
s_mov_b32 s11, 0x20000
s_mov_b32 s12, s44
s_and_b32 s13, s45, 0xffff
s_mov_b32 s14, 402653184
s_mov_b32 s15, 0x20000
v_mul_u32_u24 v1, 384, v6
v_lshlrev_b32 v2, 4, v7
v_add_u32 v1, v1, v2
v_add_u32 v60, 4096, v1
v_add_u32 v61, 8192, v1
s_add_u32 s35, s3, s5
s_and_b32 s35, s35, 1
s_mul_i32 s20, s4, 12582912
s_mul_i32 s33, s35, 6291456
s_add_u32 s20, s20, s33
s_mul_i32 s33, s4, 2
s_add_u32 s33, s33, s35
s_lshl_b32 s33, s33, 8
s_add_u32 s33, s33, 4096
v_mov_b32 v2, s33
s_mov_b32 s29, 0x7ff00000
v_mov_b32 v3, 0
v_mov_b32 v4, 0
v_mov_b32 v5, 0
v_mov_b32 v24, 0
v_mov_b32 v40, 0
v_mov_b32 v41, 0
v_mov_b32 v42, 0
v_mov_b32 v43, 0
v_mov_b32 v44, 0
v_mov_b32 v45, 0
v_mov_b32 v46, 0
v_mov_b32 v47, 0
v_mov_b32 v48, 0
v_mov_b32 v49, 0
v_mov_b32 v50, 0
v_mov_b32 v51, 0
s_mov_b32 s25, 0xff800000
v_mov_b32 v29, 0
s_mov_b32 s27, 1033096506
s_mov_b32 s28, 1069066811
s_mul_i32 s36, s3, 73728
s_add_u32 s36, s36, 16384
v_lshlrev_b32 v62, 4, v0
v_add_u32 v62, s36, v62
s_barrier
s_add_u32 s30, s5, 0
s_and_b32 s30, s30, 7
s_add_u32 s30, s30, 0
s_mul_i32 s30, s30, 12288
s_add_u32 s30, s30, s20
buffer_load_dwordx4 v[64:67], v1, s[8:11], s30 offen offset:0 nt
buffer_load_dwordx4 v[68:71], v1, s[8:11], s30 offen offset:128 nt
buffer_load_dwordx4 v[72:75], v1, s[8:11], s30 offen offset:256 nt
buffer_load_dwordx4 v[76:79], v1, s[8:11], s30 offen offset:3072 nt
buffer_load_dwordx4 v[80:83], v1, s[8:11], s30 offen offset:3200 nt
buffer_load_dwordx4 v[84:87], v1, s[8:11], s30 offen offset:3328 nt
buffer_load_dwordx4 v[88:91], v60, s[8:11], s30 offen offset:2048 nt
buffer_load_dwordx4 v[92:95], v60, s[8:11], s30 offen offset:2176 nt
buffer_load_dwordx4 v[96:99], v60, s[8:11], s30 offen offset:2304 nt
buffer_load_dwordx4 v[100:103], v61, s[8:11], s30 offen offset:1024 nt
buffer_load_dwordx4 v[104:107], v61, s[8:11], s30 offen offset:1152 nt
buffer_load_dwordx4 v[108:111], v61, s[8:11], s30 offen offset:1280 nt
buffer_load_dwordx4 a[0:3], v1, s[12:15], s30 offen offset:0 nt
buffer_load_dwordx4 a[4:7], v1, s[12:15], s30 offen offset:128 nt
buffer_load_dwordx4 a[8:11], v1, s[12:15], s30 offen offset:256 nt
buffer_load_dwordx4 a[12:15], v1, s[12:15], s30 offen offset:3072 nt
buffer_load_dwordx4 a[16:19], v1, s[12:15], s30 offen offset:3200 nt
buffer_load_dwordx4 a[20:23], v1, s[12:15], s30 offen offset:3328 nt
buffer_load_dwordx4 a[24:27], v60, s[12:15], s30 offen offset:2048 nt
buffer_load_dwordx4 a[28:31], v60, s[12:15], s30 offen offset:2176 nt
buffer_load_dwordx4 a[32:35], v60, s[12:15], s30 offen offset:2304 nt
buffer_load_dwordx4 a[36:39], v61, s[12:15], s30 offen offset:1024 nt
buffer_load_dwordx4 a[40:43], v61, s[12:15], s30 offen offset:1152 nt
buffer_load_dwordx4 a[44:47], v61, s[12:15], s30 offen offset:1280 nt
s_add_u32 s30, s5, 1
s_and_b32 s30, s30, 7
s_add_u32 s30, s30, 8
s_mul_i32 s30, s30, 12288
s_add_u32 s30, s30, s20
buffer_load_dwordx4 v[112:115], v1, s[8:11], s30 offen offset:0 nt
buffer_load_dwordx4 v[116:119], v1, s[8:11], s30 offen offset:128 nt
buffer_load_dwordx4 v[120:123], v1, s[8:11], s30 offen offset:256 nt
buffer_load_dwordx4 v[124:127], v1, s[8:11], s30 offen offset:3072 nt
buffer_load_dwordx4 v[128:131], v1, s[8:11], s30 offen offset:3200 nt
buffer_load_dwordx4 v[132:135], v1, s[8:11], s30 offen offset:3328 nt
buffer_load_dwordx4 v[136:139], v60, s[8:11], s30 offen offset:2048 nt
buffer_load_dwordx4 v[140:143], v60, s[8:11], s30 offen offset:2176 nt
buffer_load_dwordx4 v[144:147], v60, s[8:11], s30 offen offset:2304 nt
buffer_load_dwordx4 v[148:151], v61, s[8:11], s30 offen offset:1024 nt
buffer_load_dwordx4 v[152:155], v61, s[8:11], s30 offen offset:1152 nt
buffer_load_dwordx4 v[156:159], v61, s[8:11], s30 offen offset:1280 nt
buffer_load_dwordx4 a[48:51], v1, s[12:15], s30 offen offset:0 nt
buffer_load_dwordx4 a[52:55], v1, s[12:15], s30 offen offset:128 nt
buffer_load_dwordx4 a[56:59], v1, s[12:15], s30 offen offset:256 nt
buffer_load_dwordx4 a[60:63], v1, s[12:15], s30 offen offset:3072 nt
buffer_load_dwordx4 a[64:67], v1, s[12:15], s30 offen offset:3200 nt
buffer_load_dwordx4 a[68:71], v1, s[12:15], s30 offen offset:3328 nt
buffer_load_dwordx4 a[72:75], v60, s[12:15], s30 offen offset:2048 nt
buffer_load_dwordx4 a[76:79], v60, s[12:15], s30 offen offset:2176 nt
buffer_load_dwordx4 a[80:83], v60, s[12:15], s30 offen offset:2304 nt
buffer_load_dwordx4 a[84:87], v61, s[12:15], s30 offen offset:1024 nt
buffer_load_dwordx4 a[88:91], v61, s[12:15], s30 offen offset:1152 nt
buffer_load_dwordx4 a[92:95], v61, s[12:15], s30 offen offset:1280 nt
s_waitcnt vmcnt(24)
s_add_u32 s30, s5, 2
s_and_b32 s30, s30, 7
s_add_u32 s30, s30, 16
s_mul_i32 s30, s30, 12288
s_add_u32 s30, s30, s20
buffer_load_dwordx4 v[160:163], v1, s[8:11], s30 offen offset:0 nt
buffer_load_dwordx4 v[164:167], v1, s[8:11], s30 offen offset:128 nt
buffer_load_dwordx4 v[168:171], v1, s[8:11], s30 offen offset:256 nt
buffer_load_dwordx4 v[172:175], v1, s[8:11], s30 offen offset:3072 nt
buffer_load_dwordx4 v[176:179], v1, s[8:11], s30 offen offset:3200 nt
buffer_load_dwordx4 v[180:183], v1, s[8:11], s30 offen offset:3328 nt
buffer_load_dwordx4 v[184:187], v60, s[8:11], s30 offen offset:2048 nt
buffer_load_dwordx4 v[188:191], v60, s[8:11], s30 offen offset:2176 nt
buffer_load_dwordx4 v[192:195], v60, s[8:11], s30 offen offset:2304 nt
buffer_load_dwordx4 v[196:199], v61, s[8:11], s30 offen offset:1024 nt
buffer_load_dwordx4 v[200:203], v61, s[8:11], s30 offen offset:1152 nt
buffer_load_dwordx4 v[204:207], v61, s[8:11], s30 offen offset:1280 nt
buffer_load_dwordx4 a[96:99], v1, s[12:15], s30 offen offset:0 nt
buffer_load_dwordx4 a[100:103], v1, s[12:15], s30 offen offset:128 nt
buffer_load_dwordx4 a[104:107], v1, s[12:15], s30 offen offset:256 nt
buffer_load_dwordx4 a[108:111], v1, s[12:15], s30 offen offset:3072 nt
buffer_load_dwordx4 a[112:115], v1, s[12:15], s30 offen offset:3200 nt
buffer_load_dwordx4 a[116:119], v1, s[12:15], s30 offen offset:3328 nt
buffer_load_dwordx4 a[120:123], v60, s[12:15], s30 offen offset:2048 nt
buffer_load_dwordx4 a[124:127], v60, s[12:15], s30 offen offset:2176 nt
buffer_load_dwordx4 a[128:131], v60, s[12:15], s30 offen offset:2304 nt
buffer_load_dwordx4 a[132:135], v61, s[12:15], s30 offen offset:1024 nt
buffer_load_dwordx4 a[136:139], v61, s[12:15], s30 offen offset:1152 nt
buffer_load_dwordx4 a[140:143], v61, s[12:15], s30 offen offset:1280 nt
s_waitcnt vmcnt(24)
s_add_u32 s30, s5, 3
s_and_b32 s30, s30, 7
s_add_u32 s30, s30, 24
s_mul_i32 s30, s30, 12288
s_add_u32 s30, s30, s20
buffer_load_dwordx4 v[208:211], v1, s[8:11], s30 offen offset:0 nt
buffer_load_dwordx4 v[212:215], v1, s[8:11], s30 offen offset:128 nt
buffer_load_dwordx4 v[216:219], v1, s[8:11], s30 offen offset:256 nt
buffer_load_dwordx4 v[220:223], v1, s[8:11], s30 offen offset:3072 nt
buffer_load_dwordx4 v[224:227], v1, s[8:11], s30 offen offset:3200 nt
buffer_load_dwordx4 v[228:231], v1, s[8:11], s30 offen offset:3328 nt
buffer_load_dwordx4 v[232:235], v60, s[8:11], s30 offen offset:2048 nt
buffer_load_dwordx4 v[236:239], v60, s[8:11], s30 offen offset:2176 nt
buffer_load_dwordx4 v[240:243], v60, s[8:11], s30 offen offset:2304 nt
buffer_load_dwordx4 v[244:247], v61, s[8:11], s30 offen offset:1024 nt
buffer_load_dwordx4 v[248:251], v61, s[8:11], s30 offen offset:1152 nt
buffer_load_dwordx4 v[252:255], v61, s[8:11], s30 offen offset:1280 nt
buffer_load_dwordx4 a[144:147], v1, s[12:15], s30 offen offset:0 nt
buffer_load_dwordx4 a[148:151], v1, s[12:15], s30 offen offset:128 nt
buffer_load_dwordx4 a[152:155], v1, s[12:15], s30 offen offset:256 nt
buffer_load_dwordx4 a[156:159], v1, s[12:15], s30 offen offset:3072 nt
buffer_load_dwordx4 a[160:163], v1, s[12:15], s30 offen offset:3200 nt
buffer_load_dwordx4 a[164:167], v1, s[12:15], s30 offen offset:3328 nt
buffer_load_dwordx4 a[168:171], v60, s[12:15], s30 offen offset:2048 nt
buffer_load_dwordx4 a[172:175], v60, s[12:15], s30 offen offset:2176 nt
buffer_load_dwordx4 a[176:179], v60, s[12:15], s30 offen offset:2304 nt
buffer_load_dwordx4 a[180:183], v61, s[12:15], s30 offen offset:1024 nt
buffer_load_dwordx4 a[184:187], v61, s[12:15], s30 offen offset:1152 nt
buffer_load_dwordx4 a[188:191], v61, s[12:15], s30 offen offset:1280 nt
s_waitcnt vmcnt(24)
s_add_u32 s30, s5, 4
s_and_b32 s30, s30, 7
s_add_u32 s30, s30, 32
s_mul_i32 s30, s30, 12288
s_add_u32 s30, s30, s20
s_add_u32 m0, s36, 0
s_nop 0
buffer_load_dwordx4 v1, s[8:11], s30 offen offset:0 nt lds
s_add_u32 m0, s36, 896
s_nop 0
buffer_load_dwordx4 v1, s[8:11], s30 offen offset:128 nt lds
s_add_u32 m0, s36, 1792
s_nop 0
buffer_load_dwordx4 v1, s[8:11], s30 offen offset:256 nt lds
s_add_u32 m0, s36, 0
s_nop 0
buffer_load_dwordx4 v1, s[8:11], s30 offen offset:3072 nt lds
s_add_u32 m0, s36, 896
s_nop 0
buffer_load_dwordx4 v1, s[8:11], s30 offen offset:3200 nt lds
s_add_u32 m0, s36, 1792
s_nop 0
buffer_load_dwordx4 v1, s[8:11], s30 offen offset:3328 nt lds
s_add_u32 m0, s36, 4096
s_nop 0
buffer_load_dwordx4 v60, s[8:11], s30 offen offset:2048 nt lds
s_add_u32 m0, s36, 4992
s_nop 0
buffer_load_dwordx4 v60, s[8:11], s30 offen offset:2176 nt lds
s_add_u32 m0, s36, 5888
s_nop 0
buffer_load_dwordx4 v60, s[8:11], s30 offen offset:2304 nt lds
s_add_u32 m0, s36, 8192
s_nop 0
buffer_load_dwordx4 v61, s[8:11], s30 offen offset:1024 nt lds
s_add_u32 m0, s36, 9088
s_nop 0
buffer_load_dwordx4 v61, s[8:11], s30 offen offset:1152 nt lds
s_add_u32 m0, s36, 9984
s_nop 0
buffer_load_dwordx4 v61, s[8:11], s30 offen offset:1280 nt lds
s_add_u32 m0, s36, 12288
s_nop 0
buffer_load_dwordx4 v1, s[12:15], s30 offen offset:0 nt lds
s_add_u32 m0, s36, 13184
s_nop 0
buffer_load_dwordx4 v1, s[12:15], s30 offen offset:128 nt lds
s_add_u32 m0, s36, 14080
s_nop 0
buffer_load_dwordx4 v1, s[12:15], s30 offen offset:256 nt lds
s_add_u32 m0, s36, 12288
s_nop 0
buffer_load_dwordx4 v1, s[12:15], s30 offen offset:3072 nt lds
s_add_u32 m0, s36, 13184
s_nop 0
buffer_load_dwordx4 v1, s[12:15], s30 offen offset:3200 nt lds
s_add_u32 m0, s36, 14080
s_nop 0
buffer_load_dwordx4 v1, s[12:15], s30 offen offset:3328 nt lds
s_add_u32 m0, s36, 16384
s_nop 0
buffer_load_dwordx4 v60, s[12:15], s30 offen offset:2048 nt lds
s_add_u32 m0, s36, 17280
s_nop 0
buffer_load_dwordx4 v60, s[12:15], s30 offen offset:2176 nt lds
s_add_u32 m0, s36, 18176
s_nop 0
buffer_load_dwordx4 v60, s[12:15], s30 offen offset:2304 nt lds
s_add_u32 m0, s36, 20480
s_nop 0
buffer_load_dwordx4 v61, s[12:15], s30 offen offset:1024 nt lds
s_add_u32 m0, s36, 21376
s_nop 0
buffer_load_dwordx4 v61, s[12:15], s30 offen offset:1152 nt lds
s_add_u32 m0, s36, 22272
s_nop 0
buffer_load_dwordx4 v61, s[12:15], s30 offen offset:1280 nt lds
s_waitcnt vmcnt(24)
s_add_u32 s30, s5, 5
s_and_b32 s30, s30, 7
s_add_u32 s30, s30, 40
s_mul_i32 s30, s30, 12288
s_add_u32 s30, s30, s20
s_add_u32 m0, s36, 24576
s_nop 0
buffer_load_dwordx4 v1, s[8:11], s30 offen offset:0 nt lds
s_add_u32 m0, s36, 25472
s_nop 0
buffer_load_dwordx4 v1, s[8:11], s30 offen offset:128 nt lds
s_add_u32 m0, s36, 26368
s_nop 0
buffer_load_dwordx4 v1, s[8:11], s30 offen offset:256 nt lds
s_add_u32 m0, s36, 24576
s_nop 0
buffer_load_dwordx4 v1, s[8:11], s30 offen offset:3072 nt lds
s_add_u32 m0, s36, 25472
s_nop 0
buffer_load_dwordx4 v1, s[8:11], s30 offen offset:3200 nt lds
s_add_u32 m0, s36, 26368
s_nop 0
buffer_load_dwordx4 v1, s[8:11], s30 offen offset:3328 nt lds
s_add_u32 m0, s36, 28672
s_nop 0
buffer_load_dwordx4 v60, s[8:11], s30 offen offset:2048 nt lds
s_add_u32 m0, s36, 29568
s_nop 0
buffer_load_dwordx4 v60, s[8:11], s30 offen offset:2176 nt lds
s_add_u32 m0, s36, 30464
s_nop 0
buffer_load_dwordx4 v60, s[8:11], s30 offen offset:2304 nt lds
s_add_u32 m0, s36, 32768
s_nop 0
buffer_load_dwordx4 v61, s[8:11], s30 offen offset:1024 nt lds
s_add_u32 m0, s36, 33664
s_nop 0
buffer_load_dwordx4 v61, s[8:11], s30 offen offset:1152 nt lds
s_add_u32 m0, s36, 34560
s_nop 0
buffer_load_dwordx4 v61, s[8:11], s30 offen offset:1280 nt lds
s_add_u32 m0, s36, 36864
s_nop 0
buffer_load_dwordx4 v1, s[12:15], s30 offen offset:0 nt lds
s_add_u32 m0, s36, 37760
s_nop 0
buffer_load_dwordx4 v1, s[12:15], s30 offen offset:128 nt lds
s_add_u32 m0, s36, 38656
s_nop 0
buffer_load_dwordx4 v1, s[12:15], s30 offen offset:256 nt lds
s_add_u32 m0, s36, 36864
s_nop 0
buffer_load_dwordx4 v1, s[12:15], s30 offen offset:3072 nt lds
s_add_u32 m0, s36, 37760
s_nop 0
buffer_load_dwordx4 v1, s[12:15], s30 offen offset:3200 nt lds
s_add_u32 m0, s36, 38656
s_nop 0
buffer_load_dwordx4 v1, s[12:15], s30 offen offset:3328 nt lds
s_add_u32 m0, s36, 40960
s_nop 0
buffer_load_dwordx4 v60, s[12:15], s30 offen offset:2048 nt lds
s_add_u32 m0, s36, 41856
s_nop 0
buffer_load_dwordx4 v60, s[12:15], s30 offen offset:2176 nt lds
s_add_u32 m0, s36, 42752
s_nop 0
buffer_load_dwordx4 v60, s[12:15], s30 offen offset:2304 nt lds
s_add_u32 m0, s36, 45056
s_nop 0
buffer_load_dwordx4 v61, s[12:15], s30 offen offset:1024 nt lds
s_add_u32 m0, s36, 45952
s_nop 0
buffer_load_dwordx4 v61, s[12:15], s30 offen offset:1152 nt lds
s_add_u32 m0, s36, 46848
s_nop 0
buffer_load_dwordx4 v61, s[12:15], s30 offen offset:1280 nt lds
s_waitcnt vmcnt(24)
s_add_u32 s30, s5, 6
s_and_b32 s30, s30, 7
s_add_u32 s30, s30, 48
s_mul_i32 s30, s30, 12288
s_add_u32 s30, s30, s20
s_add_u32 m0, s36, 49152
s_nop 0
buffer_load_dwordx4 v1, s[8:11], s30 offen offset:0 nt lds
s_add_u32 m0, s36, 50048
s_nop 0
buffer_load_dwordx4 v1, s[8:11], s30 offen offset:128 nt lds
s_add_u32 m0, s36, 50944
s_nop 0
buffer_load_dwordx4 v1, s[8:11], s30 offen offset:256 nt lds
s_add_u32 m0, s36, 49152
s_nop 0
buffer_load_dwordx4 v1, s[8:11], s30 offen offset:3072 nt lds
s_add_u32 m0, s36, 50048
s_nop 0
buffer_load_dwordx4 v1, s[8:11], s30 offen offset:3200 nt lds
s_add_u32 m0, s36, 50944
s_nop 0
buffer_load_dwordx4 v1, s[8:11], s30 offen offset:3328 nt lds
s_add_u32 m0, s36, 53248
s_nop 0
buffer_load_dwordx4 v60, s[8:11], s30 offen offset:2048 nt lds
s_add_u32 m0, s36, 54144
s_nop 0
buffer_load_dwordx4 v60, s[8:11], s30 offen offset:2176 nt lds
s_add_u32 m0, s36, 55040
s_nop 0
buffer_load_dwordx4 v60, s[8:11], s30 offen offset:2304 nt lds
s_add_u32 m0, s36, 57344
s_nop 0
buffer_load_dwordx4 v61, s[8:11], s30 offen offset:1024 nt lds
s_add_u32 m0, s36, 58240
s_nop 0
buffer_load_dwordx4 v61, s[8:11], s30 offen offset:1152 nt lds
s_add_u32 m0, s36, 59136
s_nop 0
buffer_load_dwordx4 v61, s[8:11], s30 offen offset:1280 nt lds
s_add_u32 m0, s36, 61440
s_nop 0
buffer_load_dwordx4 v1, s[12:15], s30 offen offset:0 nt lds
s_add_u32 m0, s36, 62336
s_nop 0
buffer_load_dwordx4 v1, s[12:15], s30 offen offset:128 nt lds
s_add_u32 m0, s36, 63232
s_nop 0
buffer_load_dwordx4 v1, s[12:15], s30 offen offset:256 nt lds
s_add_u32 m0, s36, 61440
s_nop 0
buffer_load_dwordx4 v1, s[12:15], s30 offen offset:3072 nt lds
s_add_u32 m0, s36, 62336
s_nop 0
buffer_load_dwordx4 v1, s[12:15], s30 offen offset:3200 nt lds
s_add_u32 m0, s36, 63232
s_nop 0
buffer_load_dwordx4 v1, s[12:15], s30 offen offset:3328 nt lds
s_add_u32 m0, s36, 65536
s_nop 0
buffer_load_dwordx4 v60, s[12:15], s30 offen offset:2048 nt lds
s_add_u32 m0, s36, 66432
s_nop 0
buffer_load_dwordx4 v60, s[12:15], s30 offen offset:2176 nt lds
s_add_u32 m0, s36, 67328
s_nop 0
buffer_load_dwordx4 v60, s[12:15], s30 offen offset:2304 nt lds
s_add_u32 m0, s36, 69632
s_nop 0
buffer_load_dwordx4 v61, s[12:15], s30 offen offset:1024 nt lds
s_add_u32 m0, s36, 70528
s_nop 0
buffer_load_dwordx4 v61, s[12:15], s30 offen offset:1152 nt lds
s_add_u32 m0, s36, 71424
s_nop 0
buffer_load_dwordx4 v61, s[12:15], s30 offen offset:1280 nt lds
s_barrier
v_lshlrev_b32 v6, 4, v7
ds_read_b128 v[8:11], v6 offset:0
ds_read_b128 v[12:15], v6 offset:128
ds_read_b128 v[16:19], v6 offset:256
s_mov_b32 s44, s48
s_and_b32 s45, s49, 0xffff
s_mov_b32 s46, 7864320
s_mov_b32 s47, 0x20000
v_lshrrev_b32 v55, 3, v0
v_mul_u32_u24 v55, 1280, v55
v_lshlrev_b32 v56, 4, v7
v_add_u32 v55, v55, v56
s_mul_i32 s30, s4, 192
s_mul_i32 s31, s3, 64
s_add_u32 s30, s30, s31
s_mul_i32 s30, s30, 1280
s_lshl_b32 s31, s5, 8
s_add_u32 s30, s30, s31
s_cmp_lt_u32 s5, 5
s_cselect_b32 s30, s30, 0x7ff00000
buffer_load_dwordx4 a[192:195], v55, s[44:47], s30 offen nt
buffer_load_dwordx4 a[224:227], v55, s[44:47], s30 offen offset:128 nt
s_add_u32 s30, s30, 10240
buffer_load_dwordx4 a[196:199], v55, s[44:47], s30 offen nt
buffer_load_dwordx4 a[228:231], v55, s[44:47], s30 offen offset:128 nt
s_add_u32 s30, s30, 10240
buffer_load_dwordx4 a[200:203], v55, s[44:47], s30 offen nt
buffer_load_dwordx4 a[232:235], v55, s[44:47], s30 offen offset:128 nt
s_add_u32 s30, s30, 10240
buffer_load_dwordx4 a[204:207], v55, s[44:47], s30 offen nt
buffer_load_dwordx4 a[236:239], v55, s[44:47], s30 offen offset:128 nt
s_add_u32 s30, s30, 10240
buffer_load_dwordx4 a[208:211], v55, s[44:47], s30 offen nt
buffer_load_dwordx4 a[240:243], v55, s[44:47], s30 offen offset:128 nt
s_add_u32 s30, s30, 10240
buffer_load_dwordx4 a[212:215], v55, s[44:47], s30 offen nt
buffer_load_dwordx4 a[244:247], v55, s[44:47], s30 offen offset:128 nt
s_add_u32 s30, s30, 10240
buffer_load_dwordx4 a[216:219], v55, s[44:47], s30 offen nt
buffer_load_dwordx4 a[248:251], v55, s[44:47], s30 offen offset:128 nt
s_add_u32 s30, s30, 10240
buffer_load_dwordx4 a[220:223], v55, s[44:47], s30 offen nt
buffer_load_dwordx4 a[252:255], v55, s[44:47], s30 offen offset:128 nt
s_waitcnt lgkmcnt(0)
v_dot2_f32_bf16 v25, v64, v8, 0
v_dot2_f32_bf16 v26, v76, v8, 0
v_dot2_f32_bf16 v27, v88, v8, 0
v_dot2_f32_bf16 v28, v100, v8, 0
v_dot2_f32_bf16 v25, v65, v9, v25
v_dot2_f32_bf16 v26, v77, v9, v26
v_dot2_f32_bf16 v27, v89, v9, v27
v_dot2_f32_bf16 v28, v101, v9, v28
v_dot2_f32_bf16 v25, v66, v10, v25
v_dot2_f32_bf16 v26, v78, v10, v26
v_dot2_f32_bf16 v27, v90, v10, v27
v_dot2_f32_bf16 v28, v102, v10, v28
v_dot2_f32_bf16 v25, v67, v11, v25
v_dot2_f32_bf16 v26, v79, v11, v26
v_dot2_f32_bf16 v27, v91, v11, v27
v_dot2_f32_bf16 v28, v103, v11, v28
v_dot2_f32_bf16 v25, v68, v12, v25
v_dot2_f32_bf16 v26, v80, v12, v26
v_dot2_f32_bf16 v27, v92, v12, v27
v_dot2_f32_bf16 v28, v104, v12, v28
v_dot2_f32_bf16 v25, v69, v13, v25
v_dot2_f32_bf16 v26, v81, v13, v26
v_dot2_f32_bf16 v27, v93, v13, v27
v_dot2_f32_bf16 v28, v105, v13, v28
v_dot2_f32_bf16 v25, v70, v14, v25
v_dot2_f32_bf16 v26, v82, v14, v26
v_dot2_f32_bf16 v27, v94, v14, v27
v_dot2_f32_bf16 v28, v106, v14, v28
v_dot2_f32_bf16 v25, v71, v15, v25
v_dot2_f32_bf16 v26, v83, v15, v26
v_dot2_f32_bf16 v27, v95, v15, v27
v_dot2_f32_bf16 v28, v107, v15, v28
v_dot2_f32_bf16 v25, v72, v16, v25
v_dot2_f32_bf16 v26, v84, v16, v26
v_dot2_f32_bf16 v27, v96, v16, v27
v_dot2_f32_bf16 v28, v108, v16, v28
v_dot2_f32_bf16 v25, v73, v17, v25
v_dot2_f32_bf16 v26, v85, v17, v26
v_dot2_f32_bf16 v27, v97, v17, v27
v_dot2_f32_bf16 v28, v109, v17, v28
v_dot2_f32_bf16 v25, v74, v18, v25
v_dot2_f32_bf16 v26, v86, v18, v26
v_dot2_f32_bf16 v27, v98, v18, v27
v_dot2_f32_bf16 v28, v110, v18, v28
v_dot2_f32_bf16 v25, v75, v19, v25
v_dot2_f32_bf16 v26, v87, v19, v26
v_dot2_f32_bf16 v27, v99, v19, v27
v_dot2_f32_bf16 v28, v111, v19, v28
s_add_u32 s22, s5, 7
s_and_b32 s22, s22, 7
s_add_u32 s22, s22, 56
s_mul_i32 s22, s22, 12288
s_add_u32 s22, s22, s20
buffer_load_dword v3, v2, s[16:19], s29 offen
buffer_load_dwordx4 v[64:67], v1, s[8:11], s22 offen offset:0 nt
buffer_load_dwordx4 v[68:71], v1, s[8:11], s22 offen offset:128 nt
buffer_load_dwordx4 v[72:75], v1, s[8:11], s22 offen offset:256 nt
buffer_load_dwordx4 v[76:79], v1, s[8:11], s22 offen offset:3072 nt
buffer_load_dwordx4 v[80:83], v1, s[8:11], s22 offen offset:3200 nt
buffer_load_dwordx4 v[84:87], v1, s[8:11], s22 offen offset:3328 nt
buffer_load_dwordx4 v[88:91], v60, s[8:11], s22 offen offset:2048 nt
buffer_load_dwordx4 v[92:95], v60, s[8:11], s22 offen offset:2176 nt
buffer_load_dwordx4 v[96:99], v60, s[8:11], s22 offen offset:2304 nt
buffer_load_dwordx4 v[100:103], v61, s[8:11], s22 offen offset:1024 nt
buffer_load_dwordx4 v[104:107], v61, s[8:11], s22 offen offset:1152 nt
buffer_load_dwordx4 v[108:111], v61, s[8:11], s22 offen offset:1280 nt
v_add_f32_dpp v25, v25, v25 quad_perm:[1,0,3,2] row_mask:0xf bank_mask:0xf
v_add_f32_dpp v26, v26, v26 quad_perm:[1,0,3,2] row_mask:0xf bank_mask:0xf
v_add_f32_dpp v27, v27, v27 quad_perm:[1,0,3,2] row_mask:0xf bank_mask:0xf
v_add_f32_dpp v28, v28, v28 quad_perm:[1,0,3,2] row_mask:0xf bank_mask:0xf
v_add_f32_dpp v25, v25, v25 quad_perm:[2,3,0,1] row_mask:0xf bank_mask:0xf
v_add_f32_dpp v26, v26, v26 quad_perm:[2,3,0,1] row_mask:0xf bank_mask:0xf
v_add_f32_dpp v27, v27, v27 quad_perm:[2,3,0,1] row_mask:0xf bank_mask:0xf
v_add_f32_dpp v28, v28, v28 quad_perm:[2,3,0,1] row_mask:0xf bank_mask:0xf
v_add_f32_dpp v25, v25, v25 row_half_mirror row_mask:0xf bank_mask:0xf
v_add_f32_dpp v26, v26, v26 row_half_mirror row_mask:0xf bank_mask:0xf
v_add_f32_dpp v27, v27, v27 row_half_mirror row_mask:0xf bank_mask:0xf
v_add_f32_dpp v28, v28, v28 row_half_mirror row_mask:0xf bank_mask:0xf
v_cvt_pk_bf16_f32 v30, v25, v26
v_cvt_pk_bf16_f32 v31, v27, v28
v_lshlrev_b32 v25, 16, v30
v_and_b32 v26, 0xffff0000, v30
v_lshlrev_b32 v27, 16, v31
v_and_b32 v28, 0xffff0000, v31
v_mul_f32 v25, s27, v25
v_mul_f32 v26, s27, v26
v_mul_f32 v27, s27, v27
v_mul_f32 v28, s27, v28
v_cvt_pk_bf16_f32 v30, v25, v26
v_cvt_pk_bf16_f32 v31, v27, v28
v_lshlrev_b32 v25, 16, v30
v_and_b32 v26, 0xffff0000, v30
v_lshlrev_b32 v27, 16, v31
v_and_b32 v28, 0xffff0000, v31
v_max_f32 v63, v25, v26
v_max3_f32 v63, v63, v27, v28
v_cmp_lt_f32 vcc, s25, v63
s_cbranch_vccnz L_rare0
L_ret0:
v_fma_f32 v25, v25, s28, v29
v_fma_f32 v26, v26, s28, v29
v_fma_f32 v27, v27, s28, v29
v_fma_f32 v28, v28, s28, v29
v_exp_f32 v25, v25
v_exp_f32 v26, v26
v_exp_f32 v27, v27
v_exp_f32 v28, v28
v_add_f32 v30, v25, v26
v_add_f32 v31, v27, v28
v_add_f32 v30, v30, v31
v_cvt_pk_bf16_f32 v25, v25, v25
v_cvt_pk_bf16_f32 v26, v26, v26
v_cvt_pk_bf16_f32 v27, v27, v27
v_cvt_pk_bf16_f32 v28, v28, v28
v_add_f32 v24, v24, v30
v_and_b32 v32, v25, v20
v_and_b32 v33, v25, v21
v_and_b32 v34, v25, v22
v_and_b32 v35, v25, v23
v_and_b32 v36, v26, v20
v_and_b32 v37, v26, v21
v_and_b32 v38, v26, v22
v_and_b32 v39, v26, v23
v_mfma_f32_16x16x32_bf16 v[40:43], v[32:35], a[0:3], v[40:43]
v_mfma_f32_16x16x32_bf16 v[44:47], v[32:35], a[4:7], v[44:47]
v_mfma_f32_16x16x32_bf16 v[48:51], v[32:35], a[8:11], v[48:51]
v_and_b32 v32, v27, v20
v_and_b32 v33, v27, v21
v_and_b32 v34, v27, v22
v_and_b32 v35, v27, v23
v_mfma_f32_16x16x32_bf16 v[40:43], v[36:39], a[12:15], v[40:43]
v_mfma_f32_16x16x32_bf16 v[44:47], v[36:39], a[16:19], v[44:47]
v_mfma_f32_16x16x32_bf16 v[48:51], v[36:39], a[20:23], v[48:51]
v_and_b32 v36, v28, v20
v_and_b32 v37, v28, v21
v_and_b32 v38, v28, v22
v_and_b32 v39, v28, v23
v_mfma_f32_16x16x32_bf16 v[40:43], v[32:35], a[24:27], v[40:43]
v_mfma_f32_16x16x32_bf16 v[44:47], v[32:35], a[28:31], v[44:47]
v_mfma_f32_16x16x32_bf16 v[48:51], v[32:35], a[32:35], v[48:51]
v_mfma_f32_16x16x32_bf16 v[40:43], v[36:39], a[36:39], v[40:43]
v_mfma_f32_16x16x32_bf16 v[44:47], v[36:39], a[40:43], v[44:47]
v_mfma_f32_16x16x32_bf16 v[48:51], v[36:39], a[44:47], v[48:51]
buffer_load_dwordx4 a[0:3], v1, s[12:15], s22 offen offset:0 nt
buffer_load_dwordx4 a[4:7], v1, s[12:15], s22 offen offset:128 nt
buffer_load_dwordx4 a[8:11], v1, s[12:15], s22 offen offset:256 nt
buffer_load_dwordx4 a[12:15], v1, s[12:15], s22 offen offset:3072 nt
buffer_load_dwordx4 a[16:19], v1, s[12:15], s22 offen offset:3200 nt
buffer_load_dwordx4 a[20:23], v1, s[12:15], s22 offen offset:3328 nt
buffer_load_dwordx4 a[24:27], v60, s[12:15], s22 offen offset:2048 nt
buffer_load_dwordx4 a[28:31], v60, s[12:15], s22 offen offset:2176 nt
buffer_load_dwordx4 a[32:35], v60, s[12:15], s22 offen offset:2304 nt
buffer_load_dwordx4 a[36:39], v61, s[12:15], s22 offen offset:1024 nt
buffer_load_dwordx4 a[40:43], v61, s[12:15], s22 offen offset:1152 nt
buffer_load_dwordx4 a[44:47], v61, s[12:15], s22 offen offset:1280 nt
v_dot2_f32_bf16 v25, v112, v8, 0
v_dot2_f32_bf16 v26, v124, v8, 0
v_dot2_f32_bf16 v27, v136, v8, 0
v_dot2_f32_bf16 v28, v148, v8, 0
v_dot2_f32_bf16 v25, v113, v9, v25
v_dot2_f32_bf16 v26, v125, v9, v26
v_dot2_f32_bf16 v27, v137, v9, v27
v_dot2_f32_bf16 v28, v149, v9, v28
v_dot2_f32_bf16 v25, v114, v10, v25
v_dot2_f32_bf16 v26, v126, v10, v26
v_dot2_f32_bf16 v27, v138, v10, v27
v_dot2_f32_bf16 v28, v150, v10, v28
v_dot2_f32_bf16 v25, v115, v11, v25
v_dot2_f32_bf16 v26, v127, v11, v26
v_dot2_f32_bf16 v27, v139, v11, v27
v_dot2_f32_bf16 v28, v151, v11, v28
v_dot2_f32_bf16 v25, v116, v12, v25
v_dot2_f32_bf16 v26, v128, v12, v26
v_dot2_f32_bf16 v27, v140, v12, v27
v_dot2_f32_bf16 v28, v152, v12, v28
v_dot2_f32_bf16 v25, v117, v13, v25
v_dot2_f32_bf16 v26, v129, v13, v26
v_dot2_f32_bf16 v27, v141, v13, v27
v_dot2_f32_bf16 v28, v153, v13, v28
v_dot2_f32_bf16 v25, v118, v14, v25
v_dot2_f32_bf16 v26, v130, v14, v26
v_dot2_f32_bf16 v27, v142, v14, v27
v_dot2_f32_bf16 v28, v154, v14, v28
v_dot2_f32_bf16 v25, v119, v15, v25
v_dot2_f32_bf16 v26, v131, v15, v26
v_dot2_f32_bf16 v27, v143, v15, v27
v_dot2_f32_bf16 v28, v155, v15, v28
v_dot2_f32_bf16 v25, v120, v16, v25
v_dot2_f32_bf16 v26, v132, v16, v26
v_dot2_f32_bf16 v27, v144, v16, v27
v_dot2_f32_bf16 v28, v156, v16, v28
v_dot2_f32_bf16 v25, v121, v17, v25
v_dot2_f32_bf16 v26, v133, v17, v26
v_dot2_f32_bf16 v27, v145, v17, v27
v_dot2_f32_bf16 v28, v157, v17, v28
v_dot2_f32_bf16 v25, v122, v18, v25
v_dot2_f32_bf16 v26, v134, v18, v26
v_dot2_f32_bf16 v27, v146, v18, v27
v_dot2_f32_bf16 v28, v158, v18, v28
v_dot2_f32_bf16 v25, v123, v19, v25
v_dot2_f32_bf16 v26, v135, v19, v26
v_dot2_f32_bf16 v27, v147, v19, v27
v_dot2_f32_bf16 v28, v159, v19, v28
s_add_u32 s23, s5, 0
s_and_b32 s23, s23, 7
s_add_u32 s23, s23, 64
s_mul_i32 s23, s23, 12288
s_add_u32 s23, s23, s20
buffer_load_dword v4, v2, s[16:19], s29 offen
buffer_load_dwordx4 v[112:115], v1, s[8:11], s23 offen offset:0 nt
buffer_load_dwordx4 v[116:119], v1, s[8:11], s23 offen offset:128 nt
buffer_load_dwordx4 v[120:123], v1, s[8:11], s23 offen offset:256 nt
buffer_load_dwordx4 v[124:127], v1, s[8:11], s23 offen offset:3072 nt
buffer_load_dwordx4 v[128:131], v1, s[8:11], s23 offen offset:3200 nt
buffer_load_dwordx4 v[132:135], v1, s[8:11], s23 offen offset:3328 nt
buffer_load_dwordx4 v[136:139], v60, s[8:11], s23 offen offset:2048 nt
buffer_load_dwordx4 v[140:143], v60, s[8:11], s23 offen offset:2176 nt
buffer_load_dwordx4 v[144:147], v60, s[8:11], s23 offen offset:2304 nt
buffer_load_dwordx4 v[148:151], v61, s[8:11], s23 offen offset:1024 nt
buffer_load_dwordx4 v[152:155], v61, s[8:11], s23 offen offset:1152 nt
buffer_load_dwordx4 v[156:159], v61, s[8:11], s23 offen offset:1280 nt
v_add_f32_dpp v25, v25, v25 quad_perm:[1,0,3,2] row_mask:0xf bank_mask:0xf
v_add_f32_dpp v26, v26, v26 quad_perm:[1,0,3,2] row_mask:0xf bank_mask:0xf
v_add_f32_dpp v27, v27, v27 quad_perm:[1,0,3,2] row_mask:0xf bank_mask:0xf
v_add_f32_dpp v28, v28, v28 quad_perm:[1,0,3,2] row_mask:0xf bank_mask:0xf
v_add_f32_dpp v25, v25, v25 quad_perm:[2,3,0,1] row_mask:0xf bank_mask:0xf
v_add_f32_dpp v26, v26, v26 quad_perm:[2,3,0,1] row_mask:0xf bank_mask:0xf
v_add_f32_dpp v27, v27, v27 quad_perm:[2,3,0,1] row_mask:0xf bank_mask:0xf
v_add_f32_dpp v28, v28, v28 quad_perm:[2,3,0,1] row_mask:0xf bank_mask:0xf
v_add_f32_dpp v25, v25, v25 row_half_mirror row_mask:0xf bank_mask:0xf
v_add_f32_dpp v26, v26, v26 row_half_mirror row_mask:0xf bank_mask:0xf
v_add_f32_dpp v27, v27, v27 row_half_mirror row_mask:0xf bank_mask:0xf
v_add_f32_dpp v28, v28, v28 row_half_mirror row_mask:0xf bank_mask:0xf
v_cvt_pk_bf16_f32 v30, v25, v26
v_cvt_pk_bf16_f32 v31, v27, v28
v_lshlrev_b32 v25, 16, v30
v_and_b32 v26, 0xffff0000, v30
v_lshlrev_b32 v27, 16, v31
v_and_b32 v28, 0xffff0000, v31
v_mul_f32 v25, s27, v25
v_mul_f32 v26, s27, v26
v_mul_f32 v27, s27, v27
v_mul_f32 v28, s27, v28
v_cvt_pk_bf16_f32 v30, v25, v26
v_cvt_pk_bf16_f32 v31, v27, v28
v_lshlrev_b32 v25, 16, v30
v_and_b32 v26, 0xffff0000, v30
v_lshlrev_b32 v27, 16, v31
v_and_b32 v28, 0xffff0000, v31
v_max_f32 v63, v25, v26
v_max3_f32 v63, v63, v27, v28
v_cmp_lt_f32 vcc, s25, v63
s_cbranch_vccnz L_rare1
L_ret1:
v_fma_f32 v25, v25, s28, v29
v_fma_f32 v26, v26, s28, v29
v_fma_f32 v27, v27, s28, v29
v_fma_f32 v28, v28, s28, v29
v_exp_f32 v25, v25
v_exp_f32 v26, v26
v_exp_f32 v27, v27
v_exp_f32 v28, v28
v_add_f32 v30, v25, v26
v_add_f32 v31, v27, v28
v_add_f32 v30, v30, v31
v_cvt_pk_bf16_f32 v25, v25, v25
v_cvt_pk_bf16_f32 v26, v26, v26
v_cvt_pk_bf16_f32 v27, v27, v27
v_cvt_pk_bf16_f32 v28, v28, v28
v_add_f32 v24, v24, v30
v_and_b32 v32, v25, v20
v_and_b32 v33, v25, v21
v_and_b32 v34, v25, v22
v_and_b32 v35, v25, v23
v_and_b32 v36, v26, v20
v_and_b32 v37, v26, v21
v_and_b32 v38, v26, v22
v_and_b32 v39, v26, v23
v_mfma_f32_16x16x32_bf16 v[40:43], v[32:35], a[48:51], v[40:43]
v_mfma_f32_16x16x32_bf16 v[44:47], v[32:35], a[52:55], v[44:47]
v_mfma_f32_16x16x32_bf16 v[48:51], v[32:35], a[56:59], v[48:51]
v_and_b32 v32, v27, v20
v_and_b32 v33, v27, v21
v_and_b32 v34, v27, v22
v_and_b32 v35, v27, v23
v_mfma_f32_16x16x32_bf16 v[40:43], v[36:39], a[60:63], v[40:43]
v_mfma_f32_16x16x32_bf16 v[44:47], v[36:39], a[64:67], v[44:47]
v_mfma_f32_16x16x32_bf16 v[48:51], v[36:39], a[68:71], v[48:51]
v_and_b32 v36, v28, v20
v_and_b32 v37, v28, v21
v_and_b32 v38, v28, v22
v_and_b32 v39, v28, v23
v_mfma_f32_16x16x32_bf16 v[40:43], v[32:35], a[72:75], v[40:43]
v_mfma_f32_16x16x32_bf16 v[44:47], v[32:35], a[76:79], v[44:47]
v_mfma_f32_16x16x32_bf16 v[48:51], v[32:35], a[80:83], v[48:51]
v_mfma_f32_16x16x32_bf16 v[40:43], v[36:39], a[84:87], v[40:43]
v_mfma_f32_16x16x32_bf16 v[44:47], v[36:39], a[88:91], v[44:47]
v_mfma_f32_16x16x32_bf16 v[48:51], v[36:39], a[92:95], v[48:51]
buffer_load_dwordx4 a[48:51], v1, s[12:15], s23 offen offset:0 nt
buffer_load_dwordx4 a[52:55], v1, s[12:15], s23 offen offset:128 nt
buffer_load_dwordx4 a[56:59], v1, s[12:15], s23 offen offset:256 nt
buffer_load_dwordx4 a[60:63], v1, s[12:15], s23 offen offset:3072 nt
buffer_load_dwordx4 a[64:67], v1, s[12:15], s23 offen offset:3200 nt
buffer_load_dwordx4 a[68:71], v1, s[12:15], s23 offen offset:3328 nt
buffer_load_dwordx4 a[72:75], v60, s[12:15], s23 offen offset:2048 nt
buffer_load_dwordx4 a[76:79], v60, s[12:15], s23 offen offset:2176 nt
buffer_load_dwordx4 a[80:83], v60, s[12:15], s23 offen offset:2304 nt
buffer_load_dwordx4 a[84:87], v61, s[12:15], s23 offen offset:1024 nt
buffer_load_dwordx4 a[88:91], v61, s[12:15], s23 offen offset:1152 nt
buffer_load_dwordx4 a[92:95], v61, s[12:15], s23 offen offset:1280 nt
v_dot2_f32_bf16 v25, v160, v8, 0
v_dot2_f32_bf16 v26, v172, v8, 0
v_dot2_f32_bf16 v27, v184, v8, 0
v_dot2_f32_bf16 v28, v196, v8, 0
v_dot2_f32_bf16 v25, v161, v9, v25
v_dot2_f32_bf16 v26, v173, v9, v26
v_dot2_f32_bf16 v27, v185, v9, v27
v_dot2_f32_bf16 v28, v197, v9, v28
v_dot2_f32_bf16 v25, v162, v10, v25
v_dot2_f32_bf16 v26, v174, v10, v26
v_dot2_f32_bf16 v27, v186, v10, v27
v_dot2_f32_bf16 v28, v198, v10, v28
v_dot2_f32_bf16 v25, v163, v11, v25
v_dot2_f32_bf16 v26, v175, v11, v26
v_dot2_f32_bf16 v27, v187, v11, v27
v_dot2_f32_bf16 v28, v199, v11, v28
v_dot2_f32_bf16 v25, v164, v12, v25
v_dot2_f32_bf16 v26, v176, v12, v26
v_dot2_f32_bf16 v27, v188, v12, v27
v_dot2_f32_bf16 v28, v200, v12, v28
v_dot2_f32_bf16 v25, v165, v13, v25
v_dot2_f32_bf16 v26, v177, v13, v26
v_dot2_f32_bf16 v27, v189, v13, v27
v_dot2_f32_bf16 v28, v201, v13, v28
v_dot2_f32_bf16 v25, v166, v14, v25
v_dot2_f32_bf16 v26, v178, v14, v26
v_dot2_f32_bf16 v27, v190, v14, v27
v_dot2_f32_bf16 v28, v202, v14, v28
v_dot2_f32_bf16 v25, v167, v15, v25
v_dot2_f32_bf16 v26, v179, v15, v26
v_dot2_f32_bf16 v27, v191, v15, v27
v_dot2_f32_bf16 v28, v203, v15, v28
v_dot2_f32_bf16 v25, v168, v16, v25
v_dot2_f32_bf16 v26, v180, v16, v26
v_dot2_f32_bf16 v27, v192, v16, v27
v_dot2_f32_bf16 v28, v204, v16, v28
v_dot2_f32_bf16 v25, v169, v17, v25
v_dot2_f32_bf16 v26, v181, v17, v26
v_dot2_f32_bf16 v27, v193, v17, v27
v_dot2_f32_bf16 v28, v205, v17, v28
v_dot2_f32_bf16 v25, v170, v18, v25
v_dot2_f32_bf16 v26, v182, v18, v26
v_dot2_f32_bf16 v27, v194, v18, v27
v_dot2_f32_bf16 v28, v206, v18, v28
v_dot2_f32_bf16 v25, v171, v19, v25
v_dot2_f32_bf16 v26, v183, v19, v26
v_dot2_f32_bf16 v27, v195, v19, v27
v_dot2_f32_bf16 v28, v207, v19, v28
v_add_f32_dpp v25, v25, v25 quad_perm:[1,0,3,2] row_mask:0xf bank_mask:0xf
v_add_f32_dpp v26, v26, v26 quad_perm:[1,0,3,2] row_mask:0xf bank_mask:0xf
v_add_f32_dpp v27, v27, v27 quad_perm:[1,0,3,2] row_mask:0xf bank_mask:0xf
v_add_f32_dpp v28, v28, v28 quad_perm:[1,0,3,2] row_mask:0xf bank_mask:0xf
v_add_f32_dpp v25, v25, v25 quad_perm:[2,3,0,1] row_mask:0xf bank_mask:0xf
v_add_f32_dpp v26, v26, v26 quad_perm:[2,3,0,1] row_mask:0xf bank_mask:0xf
v_add_f32_dpp v27, v27, v27 quad_perm:[2,3,0,1] row_mask:0xf bank_mask:0xf
v_add_f32_dpp v28, v28, v28 quad_perm:[2,3,0,1] row_mask:0xf bank_mask:0xf
v_add_f32_dpp v25, v25, v25 row_half_mirror row_mask:0xf bank_mask:0xf
v_add_f32_dpp v26, v26, v26 row_half_mirror row_mask:0xf bank_mask:0xf
v_add_f32_dpp v27, v27, v27 row_half_mirror row_mask:0xf bank_mask:0xf
v_add_f32_dpp v28, v28, v28 row_half_mirror row_mask:0xf bank_mask:0xf
v_cvt_pk_bf16_f32 v30, v25, v26
v_cvt_pk_bf16_f32 v31, v27, v28
v_lshlrev_b32 v25, 16, v30
v_and_b32 v26, 0xffff0000, v30
v_lshlrev_b32 v27, 16, v31
v_and_b32 v28, 0xffff0000, v31
v_mul_f32 v25, s27, v25
v_mul_f32 v26, s27, v26
v_mul_f32 v27, s27, v27
v_mul_f32 v28, s27, v28
v_cvt_pk_bf16_f32 v30, v25, v26
v_cvt_pk_bf16_f32 v31, v27, v28
v_lshlrev_b32 v25, 16, v30
v_and_b32 v26, 0xffff0000, v30
v_lshlrev_b32 v27, 16, v31
v_and_b32 v28, 0xffff0000, v31
v_max_f32 v63, v25, v26
v_max3_f32 v63, v63, v27, v28
v_cmp_lt_f32 vcc, s25, v63
s_cbranch_vccnz L_rare2
L_ret2:
v_fma_f32 v25, v25, s28, v29
v_fma_f32 v26, v26, s28, v29
v_fma_f32 v27, v27, s28, v29
v_fma_f32 v28, v28, s28, v29
v_exp_f32 v25, v25
v_exp_f32 v26, v26
v_exp_f32 v27, v27
v_exp_f32 v28, v28
v_add_f32 v30, v25, v26
v_add_f32 v31, v27, v28
v_add_f32 v30, v30, v31
v_cvt_pk_bf16_f32 v25, v25, v25
v_cvt_pk_bf16_f32 v26, v26, v26
v_cvt_pk_bf16_f32 v27, v27, v27
v_cvt_pk_bf16_f32 v28, v28, v28
v_add_f32 v24, v24, v30
v_and_b32 v32, v25, v20
v_and_b32 v33, v25, v21
v_and_b32 v34, v25, v22
v_and_b32 v35, v25, v23
v_and_b32 v36, v26, v20
v_and_b32 v37, v26, v21
v_and_b32 v38, v26, v22
v_and_b32 v39, v26, v23
v_mfma_f32_16x16x32_bf16 v[40:43], v[32:35], a[96:99], v[40:43]
v_mfma_f32_16x16x32_bf16 v[44:47], v[32:35], a[100:103], v[44:47]
v_mfma_f32_16x16x32_bf16 v[48:51], v[32:35], a[104:107], v[48:51]
v_and_b32 v32, v27, v20
v_and_b32 v33, v27, v21
v_and_b32 v34, v27, v22
v_and_b32 v35, v27, v23
v_mfma_f32_16x16x32_bf16 v[40:43], v[36:39], a[108:111], v[40:43]
v_mfma_f32_16x16x32_bf16 v[44:47], v[36:39], a[112:115], v[44:47]
v_mfma_f32_16x16x32_bf16 v[48:51], v[36:39], a[116:119], v[48:51]
v_and_b32 v36, v28, v20
v_and_b32 v37, v28, v21
v_and_b32 v38, v28, v22
v_and_b32 v39, v28, v23
v_mfma_f32_16x16x32_bf16 v[40:43], v[32:35], a[120:123], v[40:43]
v_mfma_f32_16x16x32_bf16 v[44:47], v[32:35], a[124:127], v[44:47]
v_mfma_f32_16x16x32_bf16 v[48:51], v[32:35], a[128:131], v[48:51]
v_mfma_f32_16x16x32_bf16 v[40:43], v[36:39], a[132:135], v[40:43]
v_mfma_f32_16x16x32_bf16 v[44:47], v[36:39], a[136:139], v[44:47]
v_mfma_f32_16x16x32_bf16 v[48:51], v[36:39], a[140:143], v[48:51]
v_dot2_f32_bf16 v25, v208, v8, 0
v_dot2_f32_bf16 v26, v220, v8, 0
v_dot2_f32_bf16 v27, v232, v8, 0
v_dot2_f32_bf16 v28, v244, v8, 0
v_dot2_f32_bf16 v25, v209, v9, v25
v_dot2_f32_bf16 v26, v221, v9, v26
v_dot2_f32_bf16 v27, v233, v9, v27
v_dot2_f32_bf16 v28, v245, v9, v28
v_dot2_f32_bf16 v25, v210, v10, v25
v_dot2_f32_bf16 v26, v222, v10, v26
v_dot2_f32_bf16 v27, v234, v10, v27
v_dot2_f32_bf16 v28, v246, v10, v28
v_dot2_f32_bf16 v25, v211, v11, v25
v_dot2_f32_bf16 v26, v223, v11, v26
v_dot2_f32_bf16 v27, v235, v11, v27
v_dot2_f32_bf16 v28, v247, v11, v28
v_dot2_f32_bf16 v25, v212, v12, v25
v_dot2_f32_bf16 v26, v224, v12, v26
v_dot2_f32_bf16 v27, v236, v12, v27
v_dot2_f32_bf16 v28, v248, v12, v28
v_dot2_f32_bf16 v25, v213, v13, v25
v_dot2_f32_bf16 v26, v225, v13, v26
v_dot2_f32_bf16 v27, v237, v13, v27
v_dot2_f32_bf16 v28, v249, v13, v28
v_dot2_f32_bf16 v25, v214, v14, v25
v_dot2_f32_bf16 v26, v226, v14, v26
v_dot2_f32_bf16 v27, v238, v14, v27
v_dot2_f32_bf16 v28, v250, v14, v28
v_dot2_f32_bf16 v25, v215, v15, v25
v_dot2_f32_bf16 v26, v227, v15, v26
v_dot2_f32_bf16 v27, v239, v15, v27
v_dot2_f32_bf16 v28, v251, v15, v28
v_dot2_f32_bf16 v25, v216, v16, v25
v_dot2_f32_bf16 v26, v228, v16, v26
v_dot2_f32_bf16 v27, v240, v16, v27
v_dot2_f32_bf16 v28, v252, v16, v28
v_dot2_f32_bf16 v25, v217, v17, v25
v_dot2_f32_bf16 v26, v229, v17, v26
v_dot2_f32_bf16 v27, v241, v17, v27
v_dot2_f32_bf16 v28, v253, v17, v28
v_dot2_f32_bf16 v25, v218, v18, v25
v_dot2_f32_bf16 v26, v230, v18, v26
v_dot2_f32_bf16 v27, v242, v18, v27
v_dot2_f32_bf16 v28, v254, v18, v28
v_dot2_f32_bf16 v25, v219, v19, v25
v_dot2_f32_bf16 v26, v231, v19, v26
v_dot2_f32_bf16 v27, v243, v19, v27
v_dot2_f32_bf16 v28, v255, v19, v28
v_add_f32_dpp v25, v25, v25 quad_perm:[1,0,3,2] row_mask:0xf bank_mask:0xf
v_add_f32_dpp v26, v26, v26 quad_perm:[1,0,3,2] row_mask:0xf bank_mask:0xf
v_add_f32_dpp v27, v27, v27 quad_perm:[1,0,3,2] row_mask:0xf bank_mask:0xf
v_add_f32_dpp v28, v28, v28 quad_perm:[1,0,3,2] row_mask:0xf bank_mask:0xf
v_add_f32_dpp v25, v25, v25 quad_perm:[2,3,0,1] row_mask:0xf bank_mask:0xf
v_add_f32_dpp v26, v26, v26 quad_perm:[2,3,0,1] row_mask:0xf bank_mask:0xf
v_add_f32_dpp v27, v27, v27 quad_perm:[2,3,0,1] row_mask:0xf bank_mask:0xf
v_add_f32_dpp v28, v28, v28 quad_perm:[2,3,0,1] row_mask:0xf bank_mask:0xf
v_add_f32_dpp v25, v25, v25 row_half_mirror row_mask:0xf bank_mask:0xf
v_add_f32_dpp v26, v26, v26 row_half_mirror row_mask:0xf bank_mask:0xf
v_add_f32_dpp v27, v27, v27 row_half_mirror row_mask:0xf bank_mask:0xf
v_add_f32_dpp v28, v28, v28 row_half_mirror row_mask:0xf bank_mask:0xf
v_cvt_pk_bf16_f32 v30, v25, v26
v_cvt_pk_bf16_f32 v31, v27, v28
v_lshlrev_b32 v25, 16, v30
v_and_b32 v26, 0xffff0000, v30
v_lshlrev_b32 v27, 16, v31
v_and_b32 v28, 0xffff0000, v31
v_mul_f32 v25, s27, v25
v_mul_f32 v26, s27, v26
v_mul_f32 v27, s27, v27
v_mul_f32 v28, s27, v28
v_cvt_pk_bf16_f32 v30, v25, v26
v_cvt_pk_bf16_f32 v31, v27, v28
v_lshlrev_b32 v25, 16, v30
v_and_b32 v26, 0xffff0000, v30
v_lshlrev_b32 v27, 16, v31
v_and_b32 v28, 0xffff0000, v31
v_max_f32 v63, v25, v26
v_max3_f32 v63, v63, v27, v28
v_cmp_lt_f32 vcc, s25, v63
s_cbranch_vccnz L_rare3
L_ret3:
v_fma_f32 v25, v25, s28, v29
v_fma_f32 v26, v26, s28, v29
v_fma_f32 v27, v27, s28, v29
v_fma_f32 v28, v28, s28, v29
v_exp_f32 v25, v25
v_exp_f32 v26, v26
v_exp_f32 v27, v27
v_exp_f32 v28, v28
v_add_f32 v30, v25, v26
v_add_f32 v31, v27, v28
v_add_f32 v30, v30, v31
v_cvt_pk_bf16_f32 v25, v25, v25
v_cvt_pk_bf16_f32 v26, v26, v26
v_cvt_pk_bf16_f32 v27, v27, v27
v_cvt_pk_bf16_f32 v28, v28, v28
v_add_f32 v24, v24, v30
v_and_b32 v32, v25, v20
v_and_b32 v33, v25, v21
v_and_b32 v34, v25, v22
v_and_b32 v35, v25, v23
v_and_b32 v36, v26, v20
v_and_b32 v37, v26, v21
v_and_b32 v38, v26, v22
v_and_b32 v39, v26, v23
v_mfma_f32_16x16x32_bf16 v[40:43], v[32:35], a[144:147], v[40:43]
v_mfma_f32_16x16x32_bf16 v[44:47], v[32:35], a[148:151], v[44:47]
v_mfma_f32_16x16x32_bf16 v[48:51], v[32:35], a[152:155], v[48:51]
v_and_b32 v32, v27, v20
v_and_b32 v33, v27, v21
v_and_b32 v34, v27, v22
v_and_b32 v35, v27, v23
v_mfma_f32_16x16x32_bf16 v[40:43], v[36:39], a[156:159], v[40:43]
v_mfma_f32_16x16x32_bf16 v[44:47], v[36:39], a[160:163], v[44:47]
v_mfma_f32_16x16x32_bf16 v[48:51], v[36:39], a[164:167], v[48:51]
v_and_b32 v36, v28, v20
v_and_b32 v37, v28, v21
v_and_b32 v38, v28, v22
v_and_b32 v39, v28, v23
v_mfma_f32_16x16x32_bf16 v[40:43], v[32:35], a[168:171], v[40:43]
v_mfma_f32_16x16x32_bf16 v[44:47], v[32:35], a[172:175], v[44:47]
v_mfma_f32_16x16x32_bf16 v[48:51], v[32:35], a[176:179], v[48:51]
v_mfma_f32_16x16x32_bf16 v[40:43], v[36:39], a[180:183], v[40:43]
v_mfma_f32_16x16x32_bf16 v[44:47], v[36:39], a[184:187], v[44:47]
v_mfma_f32_16x16x32_bf16 v[48:51], v[36:39], a[188:191], v[48:51]
ds_read_b128 v[160:163], v62 offset:0
ds_read_b128 v[164:167], v62 offset:1024
ds_read_b128 v[168:171], v62 offset:2048
ds_read_b128 v[172:175], v62 offset:3072
ds_read_b128 v[176:179], v62 offset:4096
ds_read_b128 v[180:183], v62 offset:5120
ds_read_b128 v[184:187], v62 offset:6144
ds_read_b128 v[188:191], v62 offset:7168
ds_read_b128 v[192:195], v62 offset:8192
ds_read_b128 v[196:199], v62 offset:9216
ds_read_b128 v[200:203], v62 offset:10240
ds_read_b128 v[204:207], v62 offset:11264
ds_read_b128 a[96:99], v62 offset:12288
ds_read_b128 a[100:103], v62 offset:13312
ds_read_b128 a[104:107], v62 offset:14336
ds_read_b128 a[108:111], v62 offset:15360
ds_read_b128 a[112:115], v62 offset:16384
ds_read_b128 a[116:119], v62 offset:17408
ds_read_b128 a[120:123], v62 offset:18432
ds_read_b128 a[124:127], v62 offset:19456
ds_read_b128 a[128:131], v62 offset:20480
ds_read_b128 a[132:135], v62 offset:21504
ds_read_b128 a[136:139], v62 offset:22528
ds_read_b128 a[140:143], v62 offset:23552
v_add_u32 v62, 24576, v62
s_waitcnt lgkmcnt(12)
v_dot2_f32_bf16 v25, v160, v8, 0
v_dot2_f32_bf16 v26, v172, v8, 0
v_dot2_f32_bf16 v27, v184, v8, 0
v_dot2_f32_bf16 v28, v196, v8, 0
v_dot2_f32_bf16 v25, v161, v9, v25
v_dot2_f32_bf16 v26, v173, v9, v26
v_dot2_f32_bf16 v27, v185, v9, v27
v_dot2_f32_bf16 v28, v197, v9, v28
v_dot2_f32_bf16 v25, v162, v10, v25
v_dot2_f32_bf16 v26, v174, v10, v26
v_dot2_f32_bf16 v27, v186, v10, v27
v_dot2_f32_bf16 v28, v198, v10, v28
v_dot2_f32_bf16 v25, v163, v11, v25
v_dot2_f32_bf16 v26, v175, v11, v26
v_dot2_f32_bf16 v27, v187, v11, v27
v_dot2_f32_bf16 v28, v199, v11, v28
v_dot2_f32_bf16 v25, v164, v12, v25
v_dot2_f32_bf16 v26, v176, v12, v26
v_dot2_f32_bf16 v27, v188, v12, v27
v_dot2_f32_bf16 v28, v200, v12, v28
v_dot2_f32_bf16 v25, v165, v13, v25
v_dot2_f32_bf16 v26, v177, v13, v26
v_dot2_f32_bf16 v27, v189, v13, v27
v_dot2_f32_bf16 v28, v201, v13, v28
v_dot2_f32_bf16 v25, v166, v14, v25
v_dot2_f32_bf16 v26, v178, v14, v26
v_dot2_f32_bf16 v27, v190, v14, v27
v_dot2_f32_bf16 v28, v202, v14, v28
v_dot2_f32_bf16 v25, v167, v15, v25
v_dot2_f32_bf16 v26, v179, v15, v26
v_dot2_f32_bf16 v27, v191, v15, v27
v_dot2_f32_bf16 v28, v203, v15, v28
v_dot2_f32_bf16 v25, v168, v16, v25
v_dot2_f32_bf16 v26, v180, v16, v26
v_dot2_f32_bf16 v27, v192, v16, v27
v_dot2_f32_bf16 v28, v204, v16, v28
v_dot2_f32_bf16 v25, v169, v17, v25
v_dot2_f32_bf16 v26, v181, v17, v26
v_dot2_f32_bf16 v27, v193, v17, v27
v_dot2_f32_bf16 v28, v205, v17, v28
v_dot2_f32_bf16 v25, v170, v18, v25
v_dot2_f32_bf16 v26, v182, v18, v26
v_dot2_f32_bf16 v27, v194, v18, v27
v_dot2_f32_bf16 v28, v206, v18, v28
v_dot2_f32_bf16 v25, v171, v19, v25
v_dot2_f32_bf16 v26, v183, v19, v26
v_dot2_f32_bf16 v27, v195, v19, v27
v_dot2_f32_bf16 v28, v207, v19, v28
v_add_f32_dpp v25, v25, v25 quad_perm:[1,0,3,2] row_mask:0xf bank_mask:0xf
v_add_f32_dpp v26, v26, v26 quad_perm:[1,0,3,2] row_mask:0xf bank_mask:0xf
v_add_f32_dpp v27, v27, v27 quad_perm:[1,0,3,2] row_mask:0xf bank_mask:0xf
v_add_f32_dpp v28, v28, v28 quad_perm:[1,0,3,2] row_mask:0xf bank_mask:0xf
v_add_f32_dpp v25, v25, v25 quad_perm:[2,3,0,1] row_mask:0xf bank_mask:0xf
v_add_f32_dpp v26, v26, v26 quad_perm:[2,3,0,1] row_mask:0xf bank_mask:0xf
v_add_f32_dpp v27, v27, v27 quad_perm:[2,3,0,1] row_mask:0xf bank_mask:0xf
v_add_f32_dpp v28, v28, v28 quad_perm:[2,3,0,1] row_mask:0xf bank_mask:0xf
v_add_f32_dpp v25, v25, v25 row_half_mirror row_mask:0xf bank_mask:0xf
v_add_f32_dpp v26, v26, v26 row_half_mirror row_mask:0xf bank_mask:0xf
v_add_f32_dpp v27, v27, v27 row_half_mirror row_mask:0xf bank_mask:0xf
v_add_f32_dpp v28, v28, v28 row_half_mirror row_mask:0xf bank_mask:0xf
v_cvt_pk_bf16_f32 v30, v25, v26
v_cvt_pk_bf16_f32 v31, v27, v28
v_lshlrev_b32 v25, 16, v30
v_and_b32 v26, 0xffff0000, v30
v_lshlrev_b32 v27, 16, v31
v_and_b32 v28, 0xffff0000, v31
v_mul_f32 v25, s27, v25
v_mul_f32 v26, s27, v26
v_mul_f32 v27, s27, v27
v_mul_f32 v28, s27, v28
v_cvt_pk_bf16_f32 v30, v25, v26
v_cvt_pk_bf16_f32 v31, v27, v28
v_lshlrev_b32 v25, 16, v30
v_and_b32 v26, 0xffff0000, v30
v_lshlrev_b32 v27, 16, v31
v_and_b32 v28, 0xffff0000, v31
v_max_f32 v63, v25, v26
v_max3_f32 v63, v63, v27, v28
v_cmp_lt_f32 vcc, s25, v63
s_cbranch_vccnz L_rare4
L_ret4:
v_fma_f32 v25, v25, s28, v29
v_fma_f32 v26, v26, s28, v29
v_fma_f32 v27, v27, s28, v29
v_fma_f32 v28, v28, s28, v29
v_exp_f32 v25, v25
v_exp_f32 v26, v26
v_exp_f32 v27, v27
v_exp_f32 v28, v28
v_add_f32 v30, v25, v26
v_add_f32 v31, v27, v28
v_add_f32 v30, v30, v31
v_cvt_pk_bf16_f32 v25, v25, v25
v_cvt_pk_bf16_f32 v26, v26, v26
v_cvt_pk_bf16_f32 v27, v27, v27
v_cvt_pk_bf16_f32 v28, v28, v28
v_add_f32 v24, v24, v30
v_and_b32 v32, v25, v20
v_and_b32 v33, v25, v21
v_and_b32 v34, v25, v22
v_and_b32 v35, v25, v23
v_and_b32 v36, v26, v20
v_and_b32 v37, v26, v21
v_and_b32 v38, v26, v22
v_and_b32 v39, v26, v23
s_waitcnt lgkmcnt(0)
v_mfma_f32_16x16x32_bf16 v[40:43], v[32:35], a[96:99], v[40:43]
v_mfma_f32_16x16x32_bf16 v[44:47], v[32:35], a[100:103], v[44:47]
v_mfma_f32_16x16x32_bf16 v[48:51], v[32:35], a[104:107], v[48:51]
v_and_b32 v32, v27, v20
v_and_b32 v33, v27, v21
v_and_b32 v34, v27, v22
v_and_b32 v35, v27, v23
v_mfma_f32_16x16x32_bf16 v[40:43], v[36:39], a[108:111], v[40:43]
v_mfma_f32_16x16x32_bf16 v[44:47], v[36:39], a[112:115], v[44:47]
v_mfma_f32_16x16x32_bf16 v[48:51], v[36:39], a[116:119], v[48:51]
v_and_b32 v36, v28, v20
v_and_b32 v37, v28, v21
v_and_b32 v38, v28, v22
v_and_b32 v39, v28, v23
v_mfma_f32_16x16x32_bf16 v[40:43], v[32:35], a[120:123], v[40:43]
v_mfma_f32_16x16x32_bf16 v[44:47], v[32:35], a[124:127], v[44:47]
v_mfma_f32_16x16x32_bf16 v[48:51], v[32:35], a[128:131], v[48:51]
v_mfma_f32_16x16x32_bf16 v[40:43], v[36:39], a[132:135], v[40:43]
v_mfma_f32_16x16x32_bf16 v[44:47], v[36:39], a[136:139], v[44:47]
v_mfma_f32_16x16x32_bf16 v[48:51], v[36:39], a[140:143], v[48:51]
s_waitcnt vmcnt(63)
ds_read_b128 v[208:211], v62 offset:0
ds_read_b128 v[212:215], v62 offset:1024
ds_read_b128 v[216:219], v62 offset:2048
ds_read_b128 v[220:223], v62 offset:3072
ds_read_b128 v[224:227], v62 offset:4096
ds_read_b128 v[228:231], v62 offset:5120
ds_read_b128 v[232:235], v62 offset:6144
ds_read_b128 v[236:239], v62 offset:7168
ds_read_b128 v[240:243], v62 offset:8192
ds_read_b128 v[244:247], v62 offset:9216
ds_read_b128 v[248:251], v62 offset:10240
ds_read_b128 v[252:255], v62 offset:11264
ds_read_b128 a[144:147], v62 offset:12288
ds_read_b128 a[148:151], v62 offset:13312
ds_read_b128 a[152:155], v62 offset:14336
ds_read_b128 a[156:159], v62 offset:15360
ds_read_b128 a[160:163], v62 offset:16384
ds_read_b128 a[164:167], v62 offset:17408
ds_read_b128 a[168:171], v62 offset:18432
ds_read_b128 a[172:175], v62 offset:19456
ds_read_b128 a[176:179], v62 offset:20480
ds_read_b128 a[180:183], v62 offset:21504
ds_read_b128 a[184:187], v62 offset:22528
ds_read_b128 a[188:191], v62 offset:23552
v_add_u32 v62, 24576, v62
s_waitcnt lgkmcnt(12)
v_dot2_f32_bf16 v25, v208, v8, 0
v_dot2_f32_bf16 v26, v220, v8, 0
v_dot2_f32_bf16 v27, v232, v8, 0
v_dot2_f32_bf16 v28, v244, v8, 0
v_dot2_f32_bf16 v25, v209, v9, v25
v_dot2_f32_bf16 v26, v221, v9, v26
v_dot2_f32_bf16 v27, v233, v9, v27
v_dot2_f32_bf16 v28, v245, v9, v28
v_dot2_f32_bf16 v25, v210, v10, v25
v_dot2_f32_bf16 v26, v222, v10, v26
v_dot2_f32_bf16 v27, v234, v10, v27
v_dot2_f32_bf16 v28, v246, v10, v28
v_dot2_f32_bf16 v25, v211, v11, v25
v_dot2_f32_bf16 v26, v223, v11, v26
v_dot2_f32_bf16 v27, v235, v11, v27
v_dot2_f32_bf16 v28, v247, v11, v28
v_dot2_f32_bf16 v25, v212, v12, v25
v_dot2_f32_bf16 v26, v224, v12, v26
v_dot2_f32_bf16 v27, v236, v12, v27
v_dot2_f32_bf16 v28, v248, v12, v28
v_dot2_f32_bf16 v25, v213, v13, v25
v_dot2_f32_bf16 v26, v225, v13, v26
v_dot2_f32_bf16 v27, v237, v13, v27
v_dot2_f32_bf16 v28, v249, v13, v28
v_dot2_f32_bf16 v25, v214, v14, v25
v_dot2_f32_bf16 v26, v226, v14, v26
v_dot2_f32_bf16 v27, v238, v14, v27
v_dot2_f32_bf16 v28, v250, v14, v28
v_dot2_f32_bf16 v25, v215, v15, v25
v_dot2_f32_bf16 v26, v227, v15, v26
v_dot2_f32_bf16 v27, v239, v15, v27
v_dot2_f32_bf16 v28, v251, v15, v28
v_dot2_f32_bf16 v25, v216, v16, v25
v_dot2_f32_bf16 v26, v228, v16, v26
v_dot2_f32_bf16 v27, v240, v16, v27
v_dot2_f32_bf16 v28, v252, v16, v28
v_dot2_f32_bf16 v25, v217, v17, v25
v_dot2_f32_bf16 v26, v229, v17, v26
v_dot2_f32_bf16 v27, v241, v17, v27
v_dot2_f32_bf16 v28, v253, v17, v28
v_dot2_f32_bf16 v25, v218, v18, v25
v_dot2_f32_bf16 v26, v230, v18, v26
v_dot2_f32_bf16 v27, v242, v18, v27
v_dot2_f32_bf16 v28, v254, v18, v28
v_dot2_f32_bf16 v25, v219, v19, v25
v_dot2_f32_bf16 v26, v231, v19, v26
v_dot2_f32_bf16 v27, v243, v19, v27
v_dot2_f32_bf16 v28, v255, v19, v28
v_add_f32_dpp v25, v25, v25 quad_perm:[1,0,3,2] row_mask:0xf bank_mask:0xf
v_add_f32_dpp v26, v26, v26 quad_perm:[1,0,3,2] row_mask:0xf bank_mask:0xf
v_add_f32_dpp v27, v27, v27 quad_perm:[1,0,3,2] row_mask:0xf bank_mask:0xf
v_add_f32_dpp v28, v28, v28 quad_perm:[1,0,3,2] row_mask:0xf bank_mask:0xf
v_add_f32_dpp v25, v25, v25 quad_perm:[2,3,0,1] row_mask:0xf bank_mask:0xf
v_add_f32_dpp v26, v26, v26 quad_perm:[2,3,0,1] row_mask:0xf bank_mask:0xf
v_add_f32_dpp v27, v27, v27 quad_perm:[2,3,0,1] row_mask:0xf bank_mask:0xf
v_add_f32_dpp v28, v28, v28 quad_perm:[2,3,0,1] row_mask:0xf bank_mask:0xf
v_add_f32_dpp v25, v25, v25 row_half_mirror row_mask:0xf bank_mask:0xf
v_add_f32_dpp v26, v26, v26 row_half_mirror row_mask:0xf bank_mask:0xf
v_add_f32_dpp v27, v27, v27 row_half_mirror row_mask:0xf bank_mask:0xf
v_add_f32_dpp v28, v28, v28 row_half_mirror row_mask:0xf bank_mask:0xf
v_cvt_pk_bf16_f32 v30, v25, v26
v_cvt_pk_bf16_f32 v31, v27, v28
v_lshlrev_b32 v25, 16, v30
v_and_b32 v26, 0xffff0000, v30
v_lshlrev_b32 v27, 16, v31
v_and_b32 v28, 0xffff0000, v31
v_mul_f32 v25, s27, v25
v_mul_f32 v26, s27, v26
v_mul_f32 v27, s27, v27
v_mul_f32 v28, s27, v28
v_cvt_pk_bf16_f32 v30, v25, v26
v_cvt_pk_bf16_f32 v31, v27, v28
v_lshlrev_b32 v25, 16, v30
v_and_b32 v26, 0xffff0000, v30
v_lshlrev_b32 v27, 16, v31
v_and_b32 v28, 0xffff0000, v31
v_max_f32 v63, v25, v26
v_max3_f32 v63, v63, v27, v28
v_cmp_lt_f32 vcc, s25, v63
s_cbranch_vccnz L_rare5
L_ret5:
v_fma_f32 v25, v25, s28, v29
v_fma_f32 v26, v26, s28, v29
v_fma_f32 v27, v27, s28, v29
v_fma_f32 v28, v28, s28, v29
v_exp_f32 v25, v25
v_exp_f32 v26, v26
v_exp_f32 v27, v27
v_exp_f32 v28, v28
v_add_f32 v30, v25, v26
v_add_f32 v31, v27, v28
v_add_f32 v30, v30, v31
v_cvt_pk_bf16_f32 v25, v25, v25
v_cvt_pk_bf16_f32 v26, v26, v26
v_cvt_pk_bf16_f32 v27, v27, v27
v_cvt_pk_bf16_f32 v28, v28, v28
v_add_f32 v24, v24, v30
v_and_b32 v32, v25, v20
v_and_b32 v33, v25, v21
v_and_b32 v34, v25, v22
v_and_b32 v35, v25, v23
v_and_b32 v36, v26, v20
v_and_b32 v37, v26, v21
v_and_b32 v38, v26, v22
v_and_b32 v39, v26, v23
s_waitcnt lgkmcnt(0)
v_mfma_f32_16x16x32_bf16 v[40:43], v[32:35], a[144:147], v[40:43]
v_mfma_f32_16x16x32_bf16 v[44:47], v[32:35], a[148:151], v[44:47]
v_mfma_f32_16x16x32_bf16 v[48:51], v[32:35], a[152:155], v[48:51]
v_and_b32 v32, v27, v20
v_and_b32 v33, v27, v21
v_and_b32 v34, v27, v22
v_and_b32 v35, v27, v23
v_mfma_f32_16x16x32_bf16 v[40:43], v[36:39], a[156:159], v[40:43]
v_mfma_f32_16x16x32_bf16 v[44:47], v[36:39], a[160:163], v[44:47]
v_mfma_f32_16x16x32_bf16 v[48:51], v[36:39], a[164:167], v[48:51]
v_and_b32 v36, v28, v20
v_and_b32 v37, v28, v21
v_and_b32 v38, v28, v22
v_and_b32 v39, v28, v23
v_mfma_f32_16x16x32_bf16 v[40:43], v[32:35], a[168:171], v[40:43]
v_mfma_f32_16x16x32_bf16 v[44:47], v[32:35], a[172:175], v[44:47]
v_mfma_f32_16x16x32_bf16 v[48:51], v[32:35], a[176:179], v[48:51]
v_mfma_f32_16x16x32_bf16 v[40:43], v[36:39], a[180:183], v[40:43]
v_mfma_f32_16x16x32_bf16 v[44:47], v[36:39], a[184:187], v[44:47]
v_mfma_f32_16x16x32_bf16 v[48:51], v[36:39], a[188:191], v[48:51]
s_waitcnt vmcnt(63)
ds_read_b128 v[160:163], v62 offset:0
ds_read_b128 v[164:167], v62 offset:1024
ds_read_b128 v[168:171], v62 offset:2048
ds_read_b128 v[172:175], v62 offset:3072
ds_read_b128 v[176:179], v62 offset:4096
ds_read_b128 v[180:183], v62 offset:5120
ds_read_b128 v[184:187], v62 offset:6144
ds_read_b128 v[188:191], v62 offset:7168
ds_read_b128 v[192:195], v62 offset:8192
ds_read_b128 v[196:199], v62 offset:9216
ds_read_b128 v[200:203], v62 offset:10240
ds_read_b128 v[204:207], v62 offset:11264
ds_read_b128 a[96:99], v62 offset:12288
ds_read_b128 a[100:103], v62 offset:13312
ds_read_b128 a[104:107], v62 offset:14336
ds_read_b128 a[108:111], v62 offset:15360
ds_read_b128 a[112:115], v62 offset:16384
ds_read_b128 a[116:119], v62 offset:17408
ds_read_b128 a[120:123], v62 offset:18432
ds_read_b128 a[124:127], v62 offset:19456
ds_read_b128 a[128:131], v62 offset:20480
ds_read_b128 a[132:135], v62 offset:21504
ds_read_b128 a[136:139], v62 offset:22528
ds_read_b128 a[140:143], v62 offset:23552
v_add_u32 v62, 24576, v62
s_waitcnt lgkmcnt(12)
v_dot2_f32_bf16 v25, v160, v8, 0
v_dot2_f32_bf16 v26, v172, v8, 0
v_dot2_f32_bf16 v27, v184, v8, 0
v_dot2_f32_bf16 v28, v196, v8, 0
v_dot2_f32_bf16 v25, v161, v9, v25
v_dot2_f32_bf16 v26, v173, v9, v26
v_dot2_f32_bf16 v27, v185, v9, v27
v_dot2_f32_bf16 v28, v197, v9, v28
v_dot2_f32_bf16 v25, v162, v10, v25
v_dot2_f32_bf16 v26, v174, v10, v26
v_dot2_f32_bf16 v27, v186, v10, v27
v_dot2_f32_bf16 v28, v198, v10, v28
v_dot2_f32_bf16 v25, v163, v11, v25
v_dot2_f32_bf16 v26, v175, v11, v26
v_dot2_f32_bf16 v27, v187, v11, v27
v_dot2_f32_bf16 v28, v199, v11, v28
v_dot2_f32_bf16 v25, v164, v12, v25
v_dot2_f32_bf16 v26, v176, v12, v26
v_dot2_f32_bf16 v27, v188, v12, v27
v_dot2_f32_bf16 v28, v200, v12, v28
v_dot2_f32_bf16 v25, v165, v13, v25
v_dot2_f32_bf16 v26, v177, v13, v26
v_dot2_f32_bf16 v27, v189, v13, v27
v_dot2_f32_bf16 v28, v201, v13, v28
v_dot2_f32_bf16 v25, v166, v14, v25
v_dot2_f32_bf16 v26, v178, v14, v26
v_dot2_f32_bf16 v27, v190, v14, v27
v_dot2_f32_bf16 v28, v202, v14, v28
v_dot2_f32_bf16 v25, v167, v15, v25
v_dot2_f32_bf16 v26, v179, v15, v26
v_dot2_f32_bf16 v27, v191, v15, v27
v_dot2_f32_bf16 v28, v203, v15, v28
v_dot2_f32_bf16 v25, v168, v16, v25
v_dot2_f32_bf16 v26, v180, v16, v26
v_dot2_f32_bf16 v27, v192, v16, v27
v_dot2_f32_bf16 v28, v204, v16, v28
v_dot2_f32_bf16 v25, v169, v17, v25
v_dot2_f32_bf16 v26, v181, v17, v26
v_dot2_f32_bf16 v27, v193, v17, v27
v_dot2_f32_bf16 v28, v205, v17, v28
v_dot2_f32_bf16 v25, v170, v18, v25
v_dot2_f32_bf16 v26, v182, v18, v26
v_dot2_f32_bf16 v27, v194, v18, v27
v_dot2_f32_bf16 v28, v206, v18, v28
v_dot2_f32_bf16 v25, v171, v19, v25
v_dot2_f32_bf16 v26, v183, v19, v26
v_dot2_f32_bf16 v27, v195, v19, v27
v_dot2_f32_bf16 v28, v207, v19, v28
v_add_f32_dpp v25, v25, v25 quad_perm:[1,0,3,2] row_mask:0xf bank_mask:0xf
v_add_f32_dpp v26, v26, v26 quad_perm:[1,0,3,2] row_mask:0xf bank_mask:0xf
v_add_f32_dpp v27, v27, v27 quad_perm:[1,0,3,2] row_mask:0xf bank_mask:0xf
v_add_f32_dpp v28, v28, v28 quad_perm:[1,0,3,2] row_mask:0xf bank_mask:0xf
v_add_f32_dpp v25, v25, v25 quad_perm:[2,3,0,1] row_mask:0xf bank_mask:0xf
v_add_f32_dpp v26, v26, v26 quad_perm:[2,3,0,1] row_mask:0xf bank_mask:0xf
v_add_f32_dpp v27, v27, v27 quad_perm:[2,3,0,1] row_mask:0xf bank_mask:0xf
v_add_f32_dpp v28, v28, v28 quad_perm:[2,3,0,1] row_mask:0xf bank_mask:0xf
v_add_f32_dpp v25, v25, v25 row_half_mirror row_mask:0xf bank_mask:0xf
v_add_f32_dpp v26, v26, v26 row_half_mirror row_mask:0xf bank_mask:0xf
v_add_f32_dpp v27, v27, v27 row_half_mirror row_mask:0xf bank_mask:0xf
v_add_f32_dpp v28, v28, v28 row_half_mirror row_mask:0xf bank_mask:0xf
v_cvt_pk_bf16_f32 v30, v25, v26
v_cvt_pk_bf16_f32 v31, v27, v28
v_lshlrev_b32 v25, 16, v30
v_and_b32 v26, 0xffff0000, v30
v_lshlrev_b32 v27, 16, v31
v_and_b32 v28, 0xffff0000, v31
v_mul_f32 v25, s27, v25
v_mul_f32 v26, s27, v26
v_mul_f32 v27, s27, v27
v_mul_f32 v28, s27, v28
v_cvt_pk_bf16_f32 v30, v25, v26
v_cvt_pk_bf16_f32 v31, v27, v28
v_lshlrev_b32 v25, 16, v30
v_and_b32 v26, 0xffff0000, v30
v_lshlrev_b32 v27, 16, v31
v_and_b32 v28, 0xffff0000, v31
v_max_f32 v63, v25, v26
v_max3_f32 v63, v63, v27, v28
v_cmp_lt_f32 vcc, s25, v63
s_cbranch_vccnz L_rare6
L_ret6:
v_fma_f32 v25, v25, s28, v29
v_fma_f32 v26, v26, s28, v29
v_fma_f32 v27, v27, s28, v29
v_fma_f32 v28, v28, s28, v29
v_exp_f32 v25, v25
v_exp_f32 v26, v26
v_exp_f32 v27, v27
v_exp_f32 v28, v28
v_add_f32 v30, v25, v26
v_add_f32 v31, v27, v28
v_add_f32 v30, v30, v31
v_cvt_pk_bf16_f32 v25, v25, v25
v_cvt_pk_bf16_f32 v26, v26, v26
v_cvt_pk_bf16_f32 v27, v27, v27
v_cvt_pk_bf16_f32 v28, v28, v28
v_add_f32 v24, v24, v30
v_and_b32 v32, v25, v20
v_and_b32 v33, v25, v21
v_and_b32 v34, v25, v22
v_and_b32 v35, v25, v23
v_and_b32 v36, v26, v20
v_and_b32 v37, v26, v21
v_and_b32 v38, v26, v22
v_and_b32 v39, v26, v23
s_waitcnt lgkmcnt(0)
v_mfma_f32_16x16x32_bf16 v[40:43], v[32:35], a[96:99], v[40:43]
v_mfma_f32_16x16x32_bf16 v[44:47], v[32:35], a[100:103], v[44:47]
v_mfma_f32_16x16x32_bf16 v[48:51], v[32:35], a[104:107], v[48:51]
v_and_b32 v32, v27, v20
v_and_b32 v33, v27, v21
v_and_b32 v34, v27, v22
v_and_b32 v35, v27, v23
v_mfma_f32_16x16x32_bf16 v[40:43], v[36:39], a[108:111], v[40:43]
v_mfma_f32_16x16x32_bf16 v[44:47], v[36:39], a[112:115], v[44:47]
v_mfma_f32_16x16x32_bf16 v[48:51], v[36:39], a[116:119], v[48:51]
v_and_b32 v36, v28, v20
v_and_b32 v37, v28, v21
v_and_b32 v38, v28, v22
v_and_b32 v39, v28, v23
v_mfma_f32_16x16x32_bf16 v[40:43], v[32:35], a[120:123], v[40:43]
v_mfma_f32_16x16x32_bf16 v[44:47], v[32:35], a[124:127], v[44:47]
v_mfma_f32_16x16x32_bf16 v[48:51], v[32:35], a[128:131], v[48:51]
v_mfma_f32_16x16x32_bf16 v[40:43], v[36:39], a[132:135], v[40:43]
v_mfma_f32_16x16x32_bf16 v[44:47], v[36:39], a[136:139], v[44:47]
v_mfma_f32_16x16x32_bf16 v[48:51], v[36:39], a[140:143], v[48:51]
s_mov_b32 s37, 0
s_mov_b32 s38, 0
s_mov_b32 s39, 0
s_mov_b32 s41, 0
s_mov_b32 s42, 0
s_mov_b32 s24, 7
s_add_u32 s26, s5, 1
s_and_b32 s26, s26, 7
s_add_u32 s26, s26, 72
L_loop:
s_cmp_eq_u32 s22, 402653184
s_cbranch_scc1 L_sdone
s_waitcnt vmcnt(37)
v_dot2_f32_bf16 v25, v64, v8, 0
v_dot2_f32_bf16 v26, v76, v8, 0
v_dot2_f32_bf16 v27, v88, v8, 0
v_dot2_f32_bf16 v28, v100, v8, 0
v_dot2_f32_bf16 v25, v65, v9, v25
v_dot2_f32_bf16 v26, v77, v9, v26
v_dot2_f32_bf16 v27, v89, v9, v27
v_dot2_f32_bf16 v28, v101, v9, v28
v_dot2_f32_bf16 v25, v66, v10, v25
v_dot2_f32_bf16 v26, v78, v10, v26
v_dot2_f32_bf16 v27, v90, v10, v27
v_dot2_f32_bf16 v28, v102, v10, v28
v_dot2_f32_bf16 v25, v67, v11, v25
v_dot2_f32_bf16 v26, v79, v11, v26
v_dot2_f32_bf16 v27, v91, v11, v27
v_dot2_f32_bf16 v28, v103, v11, v28
v_dot2_f32_bf16 v25, v68, v12, v25
v_dot2_f32_bf16 v26, v80, v12, v26
v_dot2_f32_bf16 v27, v92, v12, v27
v_dot2_f32_bf16 v28, v104, v12, v28
v_dot2_f32_bf16 v25, v69, v13, v25
v_dot2_f32_bf16 v26, v81, v13, v26
v_dot2_f32_bf16 v27, v93, v13, v27
v_dot2_f32_bf16 v28, v105, v13, v28
v_dot2_f32_bf16 v25, v70, v14, v25
v_dot2_f32_bf16 v26, v82, v14, v26
v_dot2_f32_bf16 v27, v94, v14, v27
v_dot2_f32_bf16 v28, v106, v14, v28
v_dot2_f32_bf16 v25, v71, v15, v25
v_dot2_f32_bf16 v26, v83, v15, v26
v_dot2_f32_bf16 v27, v95, v15, v27
v_dot2_f32_bf16 v28, v107, v15, v28
v_dot2_f32_bf16 v25, v72, v16, v25
v_dot2_f32_bf16 v26, v84, v16, v26
v_dot2_f32_bf16 v27, v96, v16, v27
v_dot2_f32_bf16 v28, v108, v16, v28
v_dot2_f32_bf16 v25, v73, v17, v25
v_dot2_f32_bf16 v26, v85, v17, v26
v_dot2_f32_bf16 v27, v97, v17, v27
v_dot2_f32_bf16 v28, v109, v17, v28
v_dot2_f32_bf16 v25, v74, v18, v25
v_dot2_f32_bf16 v26, v86, v18, v26
v_dot2_f32_bf16 v27, v98, v18, v27
v_dot2_f32_bf16 v28, v110, v18, v28
v_dot2_f32_bf16 v25, v75, v19, v25
v_dot2_f32_bf16 v26, v87, v19, v26
v_dot2_f32_bf16 v27, v99, v19, v27
v_dot2_f32_bf16 v28, v111, v19, v28
v_readfirstlane_b32 s30, v3
s_add_u32 s30, s30, 352
s_add_u32 s31, s37, 1
s_bitcmp1_b32 s38, 1
s_cselect_b32 s30, s30, s31
s_bitcmp1_b32 s41, 1
s_cselect_b32 s30, 512, s30
s_cmp_lt_u32 s24, 42
s_cselect_b32 s30, s26, s30
s_mov_b32 s37, s30
s_mul_i32 s31, s30, 12288
s_add_u32 s31, s31, s20
s_cmp_lt_u32 s30, 512
s_cselect_b32 s22, s31, 402653184
s_add_u32 s32, s26, 1
s_and_b32 s32, s32, 7
s_andn2_b32 s26, s26, 7
s_add_u32 s26, s26, 8
s_add_u32 s26, s26, s32
s_lshl_b32 s38, s38, 1
s_lshl_b32 s41, s41, 1
s_or_b32 s41, s41, s42
s_mov_b64 exec, 1
s_cmp_lt_u32 s24, 40
s_cbranch_scc1 L_dm0
s_cmp_lg_u32 s39, 0
s_cbranch_scc1 L_rm0
s_cmp_ge_u32 s37, 512
s_cbranch_scc1 L_dm0
s_cmp_lg_u32 s42, 0
s_cbranch_scc1 L_dm0
s_cmp_lt_u32 s24, 42
s_cbranch_scc1 L_nr0
s_add_u32 s34, s24, 4
s_mul_i32 s33, s34, 800
s_mul_i32 s32, s37, 97
s_cmp_lt_u32 s33, s32
s_cbranch_scc0 L_nr0
s_sub_u32 s33, 544, s37
s_mul_i32 s33, s33, s34
s_mul_i32 s32, s37, 75
s_mul_i32 s33, s33, 16
s_cmp_gt_u32 s32, s33
s_cbranch_scc0 L_nr0
s_mov_b32 s42, 1
s_or_b32 s41, s41, 1
s_branch L_dm0
L_nr0:
s_mov_b32 s32, 1
s_sub_u32 s33, 512, s37
s_add_u32 s34, s24, 4
s_mul_i32 s33, s33, s34
s_mul_i32 s33, s33, 16
s_mul_i32 s34, s37, 96
s_cmp_le_u32 s34, s33
s_cselect_b32 s32, 2, s32
s_mul_i32 s34, s37, 128
s_cmp_le_u32 s34, s33
s_cselect_b32 s32, 4, s32
s_cmp_lt_u32 s24, 42
s_cselect_b32 s32, 1, s32
s_sub_u32 s39, s32, 1
s_or_b32 s38, s38, 1
v_mov_b32 v3, s32
buffer_atomic_add v3, v2, s[16:19], 0 offen sc0
s_branch L_atd0
L_rm0:
s_sub_u32 s39, s39, 1
L_dm0:
buffer_load_dword v3, v2, s[16:19], s29 offen
L_atd0:
s_mov_b64 exec, -1
s_add_u32 s24, s24, 1
buffer_load_dwordx4 v[64:67], v1, s[8:11], s22 offen offset:0 nt
buffer_load_dwordx4 v[68:71], v1, s[8:11], s22 offen offset:128 nt
buffer_load_dwordx4 v[72:75], v1, s[8:11], s22 offen offset:256 nt
buffer_load_dwordx4 v[76:79], v1, s[8:11], s22 offen offset:3072 nt
buffer_load_dwordx4 v[80:83], v1, s[8:11], s22 offen offset:3200 nt
buffer_load_dwordx4 v[84:87], v1, s[8:11], s22 offen offset:3328 nt
buffer_load_dwordx4 v[88:91], v60, s[8:11], s22 offen offset:2048 nt
buffer_load_dwordx4 v[92:95], v60, s[8:11], s22 offen offset:2176 nt
buffer_load_dwordx4 v[96:99], v60, s[8:11], s22 offen offset:2304 nt
buffer_load_dwordx4 v[100:103], v61, s[8:11], s22 offen offset:1024 nt
buffer_load_dwordx4 v[104:107], v61, s[8:11], s22 offen offset:1152 nt
buffer_load_dwordx4 v[108:111], v61, s[8:11], s22 offen offset:1280 nt
v_add_f32_dpp v25, v25, v25 quad_perm:[1,0,3,2] row_mask:0xf bank_mask:0xf
v_add_f32_dpp v26, v26, v26 quad_perm:[1,0,3,2] row_mask:0xf bank_mask:0xf
v_add_f32_dpp v27, v27, v27 quad_perm:[1,0,3,2] row_mask:0xf bank_mask:0xf
v_add_f32_dpp v28, v28, v28 quad_perm:[1,0,3,2] row_mask:0xf bank_mask:0xf
v_add_f32_dpp v25, v25, v25 quad_perm:[2,3,0,1] row_mask:0xf bank_mask:0xf
v_add_f32_dpp v26, v26, v26 quad_perm:[2,3,0,1] row_mask:0xf bank_mask:0xf
v_add_f32_dpp v27, v27, v27 quad_perm:[2,3,0,1] row_mask:0xf bank_mask:0xf
v_add_f32_dpp v28, v28, v28 quad_perm:[2,3,0,1] row_mask:0xf bank_mask:0xf
v_add_f32_dpp v25, v25, v25 row_half_mirror row_mask:0xf bank_mask:0xf
v_add_f32_dpp v26, v26, v26 row_half_mirror row_mask:0xf bank_mask:0xf
v_add_f32_dpp v27, v27, v27 row_half_mirror row_mask:0xf bank_mask:0xf
v_add_f32_dpp v28, v28, v28 row_half_mirror row_mask:0xf bank_mask:0xf
v_cvt_pk_bf16_f32 v30, v25, v26
v_cvt_pk_bf16_f32 v31, v27, v28
v_lshlrev_b32 v25, 16, v30
v_and_b32 v26, 0xffff0000, v30
v_lshlrev_b32 v27, 16, v31
v_and_b32 v28, 0xffff0000, v31
v_mul_f32 v25, s27, v25
v_mul_f32 v26, s27, v26
v_mul_f32 v27, s27, v27
v_mul_f32 v28, s27, v28
v_cvt_pk_bf16_f32 v30, v25, v26
v_cvt_pk_bf16_f32 v31, v27, v28
v_lshlrev_b32 v25, 16, v30
v_and_b32 v26, 0xffff0000, v30
v_lshlrev_b32 v27, 16, v31
v_and_b32 v28, 0xffff0000, v31
v_max_f32 v63, v25, v26
v_max3_f32 v63, v63, v27, v28
v_cmp_lt_f32 vcc, s25, v63
s_cbranch_vccnz L_rare7
L_ret7:
v_fma_f32 v25, v25, s28, v29
v_fma_f32 v26, v26, s28, v29
v_fma_f32 v27, v27, s28, v29
v_fma_f32 v28, v28, s28, v29
v_exp_f32 v25, v25
v_exp_f32 v26, v26
v_exp_f32 v27, v27
v_exp_f32 v28, v28
v_add_f32 v30, v25, v26
v_add_f32 v31, v27, v28
v_add_f32 v30, v30, v31
v_cvt_pk_bf16_f32 v25, v25, v25
v_cvt_pk_bf16_f32 v26, v26, v26
v_cvt_pk_bf16_f32 v27, v27, v27
v_cvt_pk_bf16_f32 v28, v28, v28
v_add_f32 v24, v24, v30
v_and_b32 v32, v25, v20
v_and_b32 v33, v25, v21
v_and_b32 v34, v25, v22
v_and_b32 v35, v25, v23
v_and_b32 v36, v26, v20
v_and_b32 v37, v26, v21
v_and_b32 v38, v26, v22
v_and_b32 v39, v26, v23
s_waitcnt vmcnt(38)
v_mfma_f32_16x16x32_bf16 v[40:43], v[32:35], a[0:3], v[40:43]
v_mfma_f32_16x16x32_bf16 v[44:47], v[32:35], a[4:7], v[44:47]
v_mfma_f32_16x16x32_bf16 v[48:51], v[32:35], a[8:11], v[48:51]
v_and_b32 v32, v27, v20
v_and_b32 v33, v27, v21
v_and_b32 v34, v27, v22
v_and_b32 v35, v27, v23
v_mfma_f32_16x16x32_bf16 v[40:43], v[36:39], a[12:15], v[40:43]
v_mfma_f32_16x16x32_bf16 v[44:47], v[36:39], a[16:19], v[44:47]
v_mfma_f32_16x16x32_bf16 v[48:51], v[36:39], a[20:23], v[48:51]
v_and_b32 v36, v28, v20
v_and_b32 v37, v28, v21
v_and_b32 v38, v28, v22
v_and_b32 v39, v28, v23
v_mfma_f32_16x16x32_bf16 v[40:43], v[32:35], a[24:27], v[40:43]
v_mfma_f32_16x16x32_bf16 v[44:47], v[32:35], a[28:31], v[44:47]
v_mfma_f32_16x16x32_bf16 v[48:51], v[32:35], a[32:35], v[48:51]
v_mfma_f32_16x16x32_bf16 v[40:43], v[36:39], a[36:39], v[40:43]
v_mfma_f32_16x16x32_bf16 v[44:47], v[36:39], a[40:43], v[44:47]
v_mfma_f32_16x16x32_bf16 v[48:51], v[36:39], a[44:47], v[48:51]
buffer_load_dwordx4 a[0:3], v1, s[12:15], s22 offen offset:0 nt
buffer_load_dwordx4 a[4:7], v1, s[12:15], s22 offen offset:128 nt
buffer_load_dwordx4 a[8:11], v1, s[12:15], s22 offen offset:256 nt
buffer_load_dwordx4 a[12:15], v1, s[12:15], s22 offen offset:3072 nt
buffer_load_dwordx4 a[16:19], v1, s[12:15], s22 offen offset:3200 nt
buffer_load_dwordx4 a[20:23], v1, s[12:15], s22 offen offset:3328 nt
buffer_load_dwordx4 a[24:27], v60, s[12:15], s22 offen offset:2048 nt
buffer_load_dwordx4 a[28:31], v60, s[12:15], s22 offen offset:2176 nt
buffer_load_dwordx4 a[32:35], v60, s[12:15], s22 offen offset:2304 nt
buffer_load_dwordx4 a[36:39], v61, s[12:15], s22 offen offset:1024 nt
buffer_load_dwordx4 a[40:43], v61, s[12:15], s22 offen offset:1152 nt
buffer_load_dwordx4 a[44:47], v61, s[12:15], s22 offen offset:1280 nt
s_cmp_eq_u32 s23, 402653184
s_cbranch_scc1 L_sdone
s_waitcnt vmcnt(37)
v_dot2_f32_bf16 v25, v112, v8, 0
v_dot2_f32_bf16 v26, v124, v8, 0
v_dot2_f32_bf16 v27, v136, v8, 0
v_dot2_f32_bf16 v28, v148, v8, 0
v_dot2_f32_bf16 v25, v113, v9, v25
v_dot2_f32_bf16 v26, v125, v9, v26
v_dot2_f32_bf16 v27, v137, v9, v27
v_dot2_f32_bf16 v28, v149, v9, v28
v_dot2_f32_bf16 v25, v114, v10, v25
v_dot2_f32_bf16 v26, v126, v10, v26
v_dot2_f32_bf16 v27, v138, v10, v27
v_dot2_f32_bf16 v28, v150, v10, v28
v_dot2_f32_bf16 v25, v115, v11, v25
v_dot2_f32_bf16 v26, v127, v11, v26
v_dot2_f32_bf16 v27, v139, v11, v27
v_dot2_f32_bf16 v28, v151, v11, v28
v_dot2_f32_bf16 v25, v116, v12, v25
v_dot2_f32_bf16 v26, v128, v12, v26
v_dot2_f32_bf16 v27, v140, v12, v27
v_dot2_f32_bf16 v28, v152, v12, v28
v_dot2_f32_bf16 v25, v117, v13, v25
v_dot2_f32_bf16 v26, v129, v13, v26
v_dot2_f32_bf16 v27, v141, v13, v27
v_dot2_f32_bf16 v28, v153, v13, v28
v_dot2_f32_bf16 v25, v118, v14, v25
v_dot2_f32_bf16 v26, v130, v14, v26
v_dot2_f32_bf16 v27, v142, v14, v27
v_dot2_f32_bf16 v28, v154, v14, v28
v_dot2_f32_bf16 v25, v119, v15, v25
v_dot2_f32_bf16 v26, v131, v15, v26
v_dot2_f32_bf16 v27, v143, v15, v27
v_dot2_f32_bf16 v28, v155, v15, v28
v_dot2_f32_bf16 v25, v120, v16, v25
v_dot2_f32_bf16 v26, v132, v16, v26
v_dot2_f32_bf16 v27, v144, v16, v27
v_dot2_f32_bf16 v28, v156, v16, v28
v_dot2_f32_bf16 v25, v121, v17, v25
v_dot2_f32_bf16 v26, v133, v17, v26
v_dot2_f32_bf16 v27, v145, v17, v27
v_dot2_f32_bf16 v28, v157, v17, v28
v_dot2_f32_bf16 v25, v122, v18, v25
v_dot2_f32_bf16 v26, v134, v18, v26
v_dot2_f32_bf16 v27, v146, v18, v27
v_dot2_f32_bf16 v28, v158, v18, v28
v_dot2_f32_bf16 v25, v123, v19, v25
v_dot2_f32_bf16 v26, v135, v19, v26
v_dot2_f32_bf16 v27, v147, v19, v27
v_dot2_f32_bf16 v28, v159, v19, v28
v_readfirstlane_b32 s30, v4
s_add_u32 s30, s30, 352
s_add_u32 s31, s37, 1
s_bitcmp1_b32 s38, 1
s_cselect_b32 s30, s30, s31
s_bitcmp1_b32 s41, 1
s_cselect_b32 s30, 512, s30
s_cmp_lt_u32 s24, 42
s_cselect_b32 s30, s26, s30
s_mov_b32 s37, s30
s_mul_i32 s31, s30, 12288
s_add_u32 s31, s31, s20
s_cmp_lt_u32 s30, 512
s_cselect_b32 s23, s31, 402653184
s_add_u32 s32, s26, 1
s_and_b32 s32, s32, 7
s_andn2_b32 s26, s26, 7
s_add_u32 s26, s26, 8
s_add_u32 s26, s26, s32
s_lshl_b32 s38, s38, 1
s_lshl_b32 s41, s41, 1
s_or_b32 s41, s41, s42
s_mov_b64 exec, 1
s_cmp_lt_u32 s24, 40
s_cbranch_scc1 L_dm1
s_cmp_lg_u32 s39, 0
s_cbranch_scc1 L_rm1
s_cmp_ge_u32 s37, 512
s_cbranch_scc1 L_dm1
s_cmp_lg_u32 s42, 0
s_cbranch_scc1 L_dm1
s_cmp_lt_u32 s24, 42
s_cbranch_scc1 L_nr1
s_add_u32 s34, s24, 4
s_mul_i32 s33, s34, 800
s_mul_i32 s32, s37, 97
s_cmp_lt_u32 s33, s32
s_cbranch_scc0 L_nr1
s_sub_u32 s33, 544, s37
s_mul_i32 s33, s33, s34
s_mul_i32 s32, s37, 75
s_mul_i32 s33, s33, 16
s_cmp_gt_u32 s32, s33
s_cbranch_scc0 L_nr1
s_mov_b32 s42, 1
s_or_b32 s41, s41, 1
s_branch L_dm1
L_nr1:
s_mov_b32 s32, 1
s_sub_u32 s33, 512, s37
s_add_u32 s34, s24, 4
s_mul_i32 s33, s33, s34
s_mul_i32 s33, s33, 16
s_mul_i32 s34, s37, 96
s_cmp_le_u32 s34, s33
s_cselect_b32 s32, 2, s32
s_mul_i32 s34, s37, 128
s_cmp_le_u32 s34, s33
s_cselect_b32 s32, 4, s32
s_cmp_lt_u32 s24, 42
s_cselect_b32 s32, 1, s32
s_sub_u32 s39, s32, 1
s_or_b32 s38, s38, 1
v_mov_b32 v4, s32
buffer_atomic_add v4, v2, s[16:19], 0 offen sc0
s_branch L_atd1
L_rm1:
s_sub_u32 s39, s39, 1
L_dm1:
buffer_load_dword v4, v2, s[16:19], s29 offen
L_atd1:
s_mov_b64 exec, -1
s_add_u32 s24, s24, 1
buffer_load_dwordx4 v[112:115], v1, s[8:11], s23 offen offset:0 nt
buffer_load_dwordx4 v[116:119], v1, s[8:11], s23 offen offset:128 nt
buffer_load_dwordx4 v[120:123], v1, s[8:11], s23 offen offset:256 nt
buffer_load_dwordx4 v[124:127], v1, s[8:11], s23 offen offset:3072 nt
buffer_load_dwordx4 v[128:131], v1, s[8:11], s23 offen offset:3200 nt
buffer_load_dwordx4 v[132:135], v1, s[8:11], s23 offen offset:3328 nt
buffer_load_dwordx4 v[136:139], v60, s[8:11], s23 offen offset:2048 nt
buffer_load_dwordx4 v[140:143], v60, s[8:11], s23 offen offset:2176 nt
buffer_load_dwordx4 v[144:147], v60, s[8:11], s23 offen offset:2304 nt
buffer_load_dwordx4 v[148:151], v61, s[8:11], s23 offen offset:1024 nt
buffer_load_dwordx4 v[152:155], v61, s[8:11], s23 offen offset:1152 nt
buffer_load_dwordx4 v[156:159], v61, s[8:11], s23 offen offset:1280 nt
v_add_f32_dpp v25, v25, v25 quad_perm:[1,0,3,2] row_mask:0xf bank_mask:0xf
v_add_f32_dpp v26, v26, v26 quad_perm:[1,0,3,2] row_mask:0xf bank_mask:0xf
v_add_f32_dpp v27, v27, v27 quad_perm:[1,0,3,2] row_mask:0xf bank_mask:0xf
v_add_f32_dpp v28, v28, v28 quad_perm:[1,0,3,2] row_mask:0xf bank_mask:0xf
v_add_f32_dpp v25, v25, v25 quad_perm:[2,3,0,1] row_mask:0xf bank_mask:0xf
v_add_f32_dpp v26, v26, v26 quad_perm:[2,3,0,1] row_mask:0xf bank_mask:0xf
v_add_f32_dpp v27, v27, v27 quad_perm:[2,3,0,1] row_mask:0xf bank_mask:0xf
v_add_f32_dpp v28, v28, v28 quad_perm:[2,3,0,1] row_mask:0xf bank_mask:0xf
v_add_f32_dpp v25, v25, v25 row_half_mirror row_mask:0xf bank_mask:0xf
v_add_f32_dpp v26, v26, v26 row_half_mirror row_mask:0xf bank_mask:0xf
v_add_f32_dpp v27, v27, v27 row_half_mirror row_mask:0xf bank_mask:0xf
v_add_f32_dpp v28, v28, v28 row_half_mirror row_mask:0xf bank_mask:0xf
v_cvt_pk_bf16_f32 v30, v25, v26
v_cvt_pk_bf16_f32 v31, v27, v28
v_lshlrev_b32 v25, 16, v30
v_and_b32 v26, 0xffff0000, v30
v_lshlrev_b32 v27, 16, v31
v_and_b32 v28, 0xffff0000, v31
v_mul_f32 v25, s27, v25
v_mul_f32 v26, s27, v26
v_mul_f32 v27, s27, v27
v_mul_f32 v28, s27, v28
v_cvt_pk_bf16_f32 v30, v25, v26
v_cvt_pk_bf16_f32 v31, v27, v28
v_lshlrev_b32 v25, 16, v30
v_and_b32 v26, 0xffff0000, v30
v_lshlrev_b32 v27, 16, v31
v_and_b32 v28, 0xffff0000, v31
v_max_f32 v63, v25, v26
v_max3_f32 v63, v63, v27, v28
v_cmp_lt_f32 vcc, s25, v63
s_cbranch_vccnz L_rare8
L_ret8:
v_fma_f32 v25, v25, s28, v29
v_fma_f32 v26, v26, s28, v29
v_fma_f32 v27, v27, s28, v29
v_fma_f32 v28, v28, s28, v29
v_exp_f32 v25, v25
v_exp_f32 v26, v26
v_exp_f32 v27, v27
v_exp_f32 v28, v28
v_add_f32 v30, v25, v26
v_add_f32 v31, v27, v28
v_add_f32 v30, v30, v31
v_cvt_pk_bf16_f32 v25, v25, v25
v_cvt_pk_bf16_f32 v26, v26, v26
v_cvt_pk_bf16_f32 v27, v27, v27
v_cvt_pk_bf16_f32 v28, v28, v28
v_add_f32 v24, v24, v30
v_and_b32 v32, v25, v20
v_and_b32 v33, v25, v21
v_and_b32 v34, v25, v22
v_and_b32 v35, v25, v23
v_and_b32 v36, v26, v20
v_and_b32 v37, v26, v21
v_and_b32 v38, v26, v22
v_and_b32 v39, v26, v23
s_waitcnt vmcnt(38)
v_mfma_f32_16x16x32_bf16 v[40:43], v[32:35], a[48:51], v[40:43]
v_mfma_f32_16x16x32_bf16 v[44:47], v[32:35], a[52:55], v[44:47]
v_mfma_f32_16x16x32_bf16 v[48:51], v[32:35], a[56:59], v[48:51]
v_and_b32 v32, v27, v20
v_and_b32 v33, v27, v21
v_and_b32 v34, v27, v22
v_and_b32 v35, v27, v23
v_mfma_f32_16x16x32_bf16 v[40:43], v[36:39], a[60:63], v[40:43]
v_mfma_f32_16x16x32_bf16 v[44:47], v[36:39], a[64:67], v[44:47]
v_mfma_f32_16x16x32_bf16 v[48:51], v[36:39], a[68:71], v[48:51]
v_and_b32 v36, v28, v20
v_and_b32 v37, v28, v21
v_and_b32 v38, v28, v22
v_and_b32 v39, v28, v23
v_mfma_f32_16x16x32_bf16 v[40:43], v[32:35], a[72:75], v[40:43]
v_mfma_f32_16x16x32_bf16 v[44:47], v[32:35], a[76:79], v[44:47]
v_mfma_f32_16x16x32_bf16 v[48:51], v[32:35], a[80:83], v[48:51]
v_mfma_f32_16x16x32_bf16 v[40:43], v[36:39], a[84:87], v[40:43]
v_mfma_f32_16x16x32_bf16 v[44:47], v[36:39], a[88:91], v[44:47]
v_mfma_f32_16x16x32_bf16 v[48:51], v[36:39], a[92:95], v[48:51]
buffer_load_dwordx4 a[48:51], v1, s[12:15], s23 offen offset:0 nt
buffer_load_dwordx4 a[52:55], v1, s[12:15], s23 offen offset:128 nt
buffer_load_dwordx4 a[56:59], v1, s[12:15], s23 offen offset:256 nt
buffer_load_dwordx4 a[60:63], v1, s[12:15], s23 offen offset:3072 nt
buffer_load_dwordx4 a[64:67], v1, s[12:15], s23 offen offset:3200 nt
buffer_load_dwordx4 a[68:71], v1, s[12:15], s23 offen offset:3328 nt
buffer_load_dwordx4 a[72:75], v60, s[12:15], s23 offen offset:2048 nt
buffer_load_dwordx4 a[76:79], v60, s[12:15], s23 offen offset:2176 nt
buffer_load_dwordx4 a[80:83], v60, s[12:15], s23 offen offset:2304 nt
buffer_load_dwordx4 a[84:87], v61, s[12:15], s23 offen offset:1024 nt
buffer_load_dwordx4 a[88:91], v61, s[12:15], s23 offen offset:1152 nt
buffer_load_dwordx4 a[92:95], v61, s[12:15], s23 offen offset:1280 nt
s_branch L_loop
L_rare0:
v_max_f32_dpp v63, v63, v63 row_ror:8 row_mask:0xf bank_mask:0xf
s_nop 1
v_max_f32_dpp v63, v63, v63 row_bcast:15 row_mask:0xa bank_mask:0xf
s_nop 1
v_max_f32_dpp v63, v63, v63 row_bcast:31 row_mask:0xc bank_mask:0xf
s_nop 0
v_readlane_b32 s34, v63, 63
v_mov_b32 v31, s25
s_nop 0
v_subrev_f32 v31, s34, v31
v_mul_f32 v31, s28, v31
v_exp_f32 v31, v31
s_mov_b32 s25, s34
v_mov_b32 v29, s34
v_mul_f32 v29, 0xbfb8aa3b, v29
v_mul_f32 v24, v24, v31
v_mul_f32 v40, v40, v31
v_mul_f32 v41, v41, v31
v_mul_f32 v42, v42, v31
v_mul_f32 v43, v43, v31
v_mul_f32 v44, v44, v31
v_mul_f32 v45, v45, v31
v_mul_f32 v46, v46, v31
v_mul_f32 v47, v47, v31
v_mul_f32 v48, v48, v31
v_mul_f32 v49, v49, v31
v_mul_f32 v50, v50, v31
v_mul_f32 v51, v51, v31
s_branch L_ret0
L_rare1:
v_max_f32_dpp v63, v63, v63 row_ror:8 row_mask:0xf bank_mask:0xf
s_nop 1
v_max_f32_dpp v63, v63, v63 row_bcast:15 row_mask:0xa bank_mask:0xf
s_nop 1
v_max_f32_dpp v63, v63, v63 row_bcast:31 row_mask:0xc bank_mask:0xf
s_nop 0
v_readlane_b32 s34, v63, 63
v_mov_b32 v31, s25
s_nop 0
v_subrev_f32 v31, s34, v31
v_mul_f32 v31, s28, v31
v_exp_f32 v31, v31
s_mov_b32 s25, s34
v_mov_b32 v29, s34
v_mul_f32 v29, 0xbfb8aa3b, v29
v_mul_f32 v24, v24, v31
v_mul_f32 v40, v40, v31
v_mul_f32 v41, v41, v31
v_mul_f32 v42, v42, v31
v_mul_f32 v43, v43, v31
v_mul_f32 v44, v44, v31
v_mul_f32 v45, v45, v31
v_mul_f32 v46, v46, v31
v_mul_f32 v47, v47, v31
v_mul_f32 v48, v48, v31
v_mul_f32 v49, v49, v31
v_mul_f32 v50, v50, v31
v_mul_f32 v51, v51, v31
s_branch L_ret1
L_rare2:
v_max_f32_dpp v63, v63, v63 row_ror:8 row_mask:0xf bank_mask:0xf
s_nop 1
v_max_f32_dpp v63, v63, v63 row_bcast:15 row_mask:0xa bank_mask:0xf
s_nop 1
v_max_f32_dpp v63, v63, v63 row_bcast:31 row_mask:0xc bank_mask:0xf
s_nop 0
v_readlane_b32 s34, v63, 63
v_mov_b32 v31, s25
s_nop 0
v_subrev_f32 v31, s34, v31
v_mul_f32 v31, s28, v31
v_exp_f32 v31, v31
s_mov_b32 s25, s34
v_mov_b32 v29, s34
v_mul_f32 v29, 0xbfb8aa3b, v29
v_mul_f32 v24, v24, v31
v_mul_f32 v40, v40, v31
v_mul_f32 v41, v41, v31
v_mul_f32 v42, v42, v31
v_mul_f32 v43, v43, v31
v_mul_f32 v44, v44, v31
v_mul_f32 v45, v45, v31
v_mul_f32 v46, v46, v31
v_mul_f32 v47, v47, v31
v_mul_f32 v48, v48, v31
v_mul_f32 v49, v49, v31
v_mul_f32 v50, v50, v31
v_mul_f32 v51, v51, v31
s_branch L_ret2
L_rare3:
v_max_f32_dpp v63, v63, v63 row_ror:8 row_mask:0xf bank_mask:0xf
s_nop 1
v_max_f32_dpp v63, v63, v63 row_bcast:15 row_mask:0xa bank_mask:0xf
s_nop 1
v_max_f32_dpp v63, v63, v63 row_bcast:31 row_mask:0xc bank_mask:0xf
s_nop 0
v_readlane_b32 s34, v63, 63
v_mov_b32 v31, s25
s_nop 0
v_subrev_f32 v31, s34, v31
v_mul_f32 v31, s28, v31
v_exp_f32 v31, v31
s_mov_b32 s25, s34
v_mov_b32 v29, s34
v_mul_f32 v29, 0xbfb8aa3b, v29
v_mul_f32 v24, v24, v31
v_mul_f32 v40, v40, v31
v_mul_f32 v41, v41, v31
v_mul_f32 v42, v42, v31
v_mul_f32 v43, v43, v31
v_mul_f32 v44, v44, v31
v_mul_f32 v45, v45, v31
v_mul_f32 v46, v46, v31
v_mul_f32 v47, v47, v31
v_mul_f32 v48, v48, v31
v_mul_f32 v49, v49, v31
v_mul_f32 v50, v50, v31
v_mul_f32 v51, v51, v31
s_branch L_ret3
L_rare4:
v_max_f32_dpp v63, v63, v63 row_ror:8 row_mask:0xf bank_mask:0xf
s_nop 1
v_max_f32_dpp v63, v63, v63 row_bcast:15 row_mask:0xa bank_mask:0xf
s_nop 1
v_max_f32_dpp v63, v63, v63 row_bcast:31 row_mask:0xc bank_mask:0xf
s_nop 0
v_readlane_b32 s34, v63, 63
v_mov_b32 v31, s25
s_nop 0
v_subrev_f32 v31, s34, v31
v_mul_f32 v31, s28, v31
v_exp_f32 v31, v31
s_mov_b32 s25, s34
v_mov_b32 v29, s34
v_mul_f32 v29, 0xbfb8aa3b, v29
v_mul_f32 v24, v24, v31
v_mul_f32 v40, v40, v31
v_mul_f32 v41, v41, v31
v_mul_f32 v42, v42, v31
v_mul_f32 v43, v43, v31
v_mul_f32 v44, v44, v31
v_mul_f32 v45, v45, v31
v_mul_f32 v46, v46, v31
v_mul_f32 v47, v47, v31
v_mul_f32 v48, v48, v31
v_mul_f32 v49, v49, v31
v_mul_f32 v50, v50, v31
v_mul_f32 v51, v51, v31
s_branch L_ret4
L_rare5:
v_max_f32_dpp v63, v63, v63 row_ror:8 row_mask:0xf bank_mask:0xf
s_nop 1
v_max_f32_dpp v63, v63, v63 row_bcast:15 row_mask:0xa bank_mask:0xf
s_nop 1
v_max_f32_dpp v63, v63, v63 row_bcast:31 row_mask:0xc bank_mask:0xf
s_nop 0
v_readlane_b32 s34, v63, 63
v_mov_b32 v31, s25
s_nop 0
v_subrev_f32 v31, s34, v31
v_mul_f32 v31, s28, v31
v_exp_f32 v31, v31
s_mov_b32 s25, s34
v_mov_b32 v29, s34
v_mul_f32 v29, 0xbfb8aa3b, v29
v_mul_f32 v24, v24, v31
v_mul_f32 v40, v40, v31
v_mul_f32 v41, v41, v31
v_mul_f32 v42, v42, v31
v_mul_f32 v43, v43, v31
v_mul_f32 v44, v44, v31
v_mul_f32 v45, v45, v31
v_mul_f32 v46, v46, v31
v_mul_f32 v47, v47, v31
v_mul_f32 v48, v48, v31
v_mul_f32 v49, v49, v31
v_mul_f32 v50, v50, v31
v_mul_f32 v51, v51, v31
s_branch L_ret5
L_rare6:
v_max_f32_dpp v63, v63, v63 row_ror:8 row_mask:0xf bank_mask:0xf
s_nop 1
v_max_f32_dpp v63, v63, v63 row_bcast:15 row_mask:0xa bank_mask:0xf
s_nop 1
v_max_f32_dpp v63, v63, v63 row_bcast:31 row_mask:0xc bank_mask:0xf
s_nop 0
v_readlane_b32 s34, v63, 63
v_mov_b32 v31, s25
s_nop 0
v_subrev_f32 v31, s34, v31
v_mul_f32 v31, s28, v31
v_exp_f32 v31, v31
s_mov_b32 s25, s34
v_mov_b32 v29, s34
v_mul_f32 v29, 0xbfb8aa3b, v29
v_mul_f32 v24, v24, v31
v_mul_f32 v40, v40, v31
v_mul_f32 v41, v41, v31
v_mul_f32 v42, v42, v31
v_mul_f32 v43, v43, v31
v_mul_f32 v44, v44, v31
v_mul_f32 v45, v45, v31
v_mul_f32 v46, v46, v31
v_mul_f32 v47, v47, v31
v_mul_f32 v48, v48, v31
v_mul_f32 v49, v49, v31
v_mul_f32 v50, v50, v31
v_mul_f32 v51, v51, v31
s_branch L_ret6
L_rare7:
v_max_f32_dpp v63, v63, v63 row_ror:8 row_mask:0xf bank_mask:0xf
s_nop 1
v_max_f32_dpp v63, v63, v63 row_bcast:15 row_mask:0xa bank_mask:0xf
s_nop 1
v_max_f32_dpp v63, v63, v63 row_bcast:31 row_mask:0xc bank_mask:0xf
s_nop 0
v_readlane_b32 s34, v63, 63
v_mov_b32 v31, s25
s_nop 0
v_subrev_f32 v31, s34, v31
v_mul_f32 v31, s28, v31
v_exp_f32 v31, v31
s_mov_b32 s25, s34
v_mov_b32 v29, s34
v_mul_f32 v29, 0xbfb8aa3b, v29
v_mul_f32 v24, v24, v31
v_mul_f32 v40, v40, v31
v_mul_f32 v41, v41, v31
v_mul_f32 v42, v42, v31
v_mul_f32 v43, v43, v31
v_mul_f32 v44, v44, v31
v_mul_f32 v45, v45, v31
v_mul_f32 v46, v46, v31
v_mul_f32 v47, v47, v31
v_mul_f32 v48, v48, v31
v_mul_f32 v49, v49, v31
v_mul_f32 v50, v50, v31
v_mul_f32 v51, v51, v31
s_branch L_ret7
L_rare8:
v_max_f32_dpp v63, v63, v63 row_ror:8 row_mask:0xf bank_mask:0xf
s_nop 1
v_max_f32_dpp v63, v63, v63 row_bcast:15 row_mask:0xa bank_mask:0xf
s_nop 1
v_max_f32_dpp v63, v63, v63 row_bcast:31 row_mask:0xc bank_mask:0xf
s_nop 0
v_readlane_b32 s34, v63, 63
v_mov_b32 v31, s25
s_nop 0
v_subrev_f32 v31, s34, v31
v_mul_f32 v31, s28, v31
v_exp_f32 v31, v31
s_mov_b32 s25, s34
v_mov_b32 v29, s34
v_mul_f32 v29, 0xbfb8aa3b, v29
v_mul_f32 v24, v24, v31
v_mul_f32 v40, v40, v31
v_mul_f32 v41, v41, v31
v_mul_f32 v42, v42, v31
v_mul_f32 v43, v43, v31
v_mul_f32 v44, v44, v31
v_mul_f32 v45, v45, v31
v_mul_f32 v46, v46, v31
v_mul_f32 v47, v47, v31
v_mul_f32 v48, v48, v31
v_mul_f32 v49, v49, v31
v_mul_f32 v50, v50, v31
v_mul_f32 v51, v51, v31
s_branch L_ret8
L_sdone:
s_nop 7
v_add_f32_dpp v24, v24, v24 row_ror:8 row_mask:0xf bank_mask:0xf
s_nop 1
v_add_f32_dpp v24, v24, v24 row_bcast:15 row_mask:0xa bank_mask:0xf
s_nop 1
v_add_f32_dpp v24, v24, v24 row_bcast:31 row_mask:0xc bank_mask:0xf
s_nop 0
v_readlane_b32 s30, v24, 63
v_lshrrev_b32 v6, 5, v0
v_mul_u32_u24 v6, 768, v6
v_lshlrev_b32 v27, 5, v7
v_add_u32 v6, v6, v27
v_bfe_u32 v27, v0, 4, 1
v_lshlrev_b32 v27, 4, v27
v_add_u32 v6, v6, v27
s_mul_i32 s31, s3, 1536
s_add_u32 s31, s31, 9728
v_add_u32 v6, s31, v6
s_mov_b32 exec_lo, 0xff00ff
s_mov_b32 exec_hi, 0xff00ff00
ds_write_b128 v6, v[40:43] offset:0
ds_write_b128 v6, v[44:47] offset:256
ds_write_b128 v6, v[48:51] offset:512
s_mov_b64 exec, 1
v_mov_b32 v26, s25
v_mov_b32 v27, s30
s_lshl_b32 s31, s3, 3
s_add_u32 s31, s31, 512
v_mov_b32 v6, s31
ds_write_b64 v6, v[26:27]
s_mov_b64 exec, -1
s_waitcnt lgkmcnt(0)
s_barrier
s_cmp_ge_u32 s5, 5
s_cbranch_scc1 L_send
v_mov_b32 v40, 0
v_mov_b32 v41, 0
v_mov_b32 v42, 0
v_mov_b32 v43, 0
v_mov_b32 v44, 0
v_mov_b32 v45, 0
v_mov_b32 v46, 0
v_mov_b32 v47, 0
v_lshrrev_b32 v27, 3, v0
v_lshlrev_b32 v27, 2, v27
s_mul_i32 s31, s3, 256
v_add_u32 v27, s31, v27
v_lshrrev_b32 v6, 5, v0
v_lshlrev_b32 v6, 9, v6
v_lshlrev_b32 v28, 5, v7
v_add_u32 v6, v6, v28
v_bfe_u32 v28, v0, 4, 1
v_lshlrev_b32 v28, 4, v28
v_add_u32 v6, v6, v28
s_lshl_b32 s31, s3, 10
s_add_u32 s31, s31, 9728
v_add_u32 v6, s31, v6
s_waitcnt lgkmcnt(0)
s_barrier
ds_read_b32 v52, v27 offset:3584
ds_read_b32 v53, v27 offset:3616
ds_read_b32 v54, v27 offset:3648
ds_read_b32 v55, v27 offset:3680
ds_read_b32 v56, v27 offset:3712
ds_read_b32 v57, v27 offset:3744
ds_read_b32 v58, v27 offset:3776
ds_read_b32 v59, v27 offset:3808
s_waitcnt lgkmcnt(6)
v_and_b32 v32, v52, v20
v_and_b32 v33, v52, v21
v_and_b32 v34, v52, v22
v_and_b32 v35, v52, v23
s_nop 1
v_mfma_f32_16x16x32_bf16 v[40:43], v[32:35], a[192:195], v[40:43]
v_mfma_f32_16x16x32_bf16 v[44:47], v[32:35], a[224:227], v[44:47]
v_and_b32 v36, v53, v20
v_and_b32 v37, v53, v21
v_and_b32 v38, v53, v22
v_and_b32 v39, v53, v23
s_nop 1
v_mfma_f32_16x16x32_bf16 v[40:43], v[36:39], a[196:199], v[40:43]
v_mfma_f32_16x16x32_bf16 v[44:47], v[36:39], a[228:231], v[44:47]
s_waitcnt lgkmcnt(4)
v_and_b32 v32, v54, v20
v_and_b32 v33, v54, v21
v_and_b32 v34, v54, v22
v_and_b32 v35, v54, v23
s_nop 1
v_mfma_f32_16x16x32_bf16 v[40:43], v[32:35], a[200:203], v[40:43]
v_mfma_f32_16x16x32_bf16 v[44:47], v[32:35], a[232:235], v[44:47]
v_and_b32 v36, v55, v20
v_and_b32 v37, v55, v21
v_and_b32 v38, v55, v22
v_and_b32 v39, v55, v23
s_nop 1
v_mfma_f32_16x16x32_bf16 v[40:43], v[36:39], a[204:207], v[40:43]
v_mfma_f32_16x16x32_bf16 v[44:47], v[36:39], a[236:239], v[44:47]
s_waitcnt lgkmcnt(2)
v_and_b32 v32, v56, v20
v_and_b32 v33, v56, v21
v_and_b32 v34, v56, v22
v_and_b32 v35, v56, v23
s_nop 1
v_mfma_f32_16x16x32_bf16 v[40:43], v[32:35], a[208:211], v[40:43]
v_mfma_f32_16x16x32_bf16 v[44:47], v[32:35], a[240:243], v[44:47]
v_and_b32 v36, v57, v20
v_and_b32 v37, v57, v21
v_and_b32 v38, v57, v22
v_and_b32 v39, v57, v23
s_nop 1
v_mfma_f32_16x16x32_bf16 v[40:43], v[36:39], a[212:215], v[40:43]
v_mfma_f32_16x16x32_bf16 v[44:47], v[36:39], a[244:247], v[44:47]
s_waitcnt lgkmcnt(0)
v_and_b32 v32, v58, v20
v_and_b32 v33, v58, v21
v_and_b32 v34, v58, v22
v_and_b32 v35, v58, v23
s_nop 1
v_mfma_f32_16x16x32_bf16 v[40:43], v[32:35], a[216:219], v[40:43]
v_mfma_f32_16x16x32_bf16 v[44:47], v[32:35], a[248:251], v[44:47]
v_and_b32 v36, v59, v20
v_and_b32 v37, v59, v21
v_and_b32 v38, v59, v22
v_and_b32 v39, v59, v23
s_nop 1
v_mfma_f32_16x16x32_bf16 v[40:43], v[36:39], a[220:223], v[40:43]
v_mfma_f32_16x16x32_bf16 v[44:47], v[36:39], a[252:255], v[44:47]
s_mov_b32 exec_lo, 0xff00ff
s_mov_b32 exec_hi, 0xff00ff00
s_nop 4
ds_write_b128 v6, v[40:43]
ds_write_b128 v6, v[44:47] offset:256
s_waitcnt lgkmcnt(0)
s_barrier
L_send:
s_endpgm
L_helper:
s_setprio 3
s_mov_b32 s12, s46
s_and_b32 s13, s47, 0xffff
s_mov_b32 s14, 7864320
s_mov_b32 s15, 0x20000
s_mov_b32 s8, s40
s_and_b32 s9, s41, 0xffff
s_mov_b32 s10, 1280
s_mov_b32 s11, 0x20000
s_mov_b32 s24, s52
s_and_b32 s25, s53, 0xffff
s_mov_b32 s26, 1966080
s_mov_b32 s27, 0x20000
s_mov_b32 s28, s54
s_and_b32 s29, s55, 0xffff
s_mov_b32 s30, 1966080
s_mov_b32 s31, 0x20000
s_mul_i32 s65, s4, 512
s_add_u32 s65, s65, 4096
s_cmp_eq_u32 s5, 0
s_cselect_b32 s65, s65, 0x7ff00000
v_lshlrev_b32 v5, 8, v0
v_mov_b32 v13, 0
s_mov_b64 exec, 3
buffer_store_dword v13, v5, s[16:19], s65 offen sc1
s_mov_b64 exec, -1
v_mov_b32 v1, 0
buffer_load_dword v2, v1, s[16:19], 0 offen sc1
v_lshlrev_b32 v3, 2, v0
buffer_load_dword v8, v3, s[8:11], 0 offen offset:0
buffer_load_dword v9, v3, s[8:11], 0 offen offset:256
buffer_load_dword v10, v3, s[8:11], 0 offen offset:512
buffer_load_dword v11, v3, s[8:11], 0 offen offset:768
buffer_load_dword v12, v3, s[8:11], 0 offen offset:1024
v_mul_u32_u24 v4, 12288, v6
v_lshlrev_b32 v5, 4, v7
v_add_u32 v4, v4, v5
s_mul_i32 s64, s5, 983040
s_mul_i32 s65, s4, 384
s_add_u32 s64, s64, s65
buffer_load_dwordx4 v[40:43], v4, s[12:15], s64 offen offset:0 nt
buffer_load_dwordx4 v[44:47], v4, s[12:15], s64 offen offset:128 nt
buffer_load_dwordx4 v[48:51], v4, s[12:15], s64 offen offset:256 nt
s_add_u32 s64, s64, 98304
buffer_load_dwordx4 v[52:55], v4, s[12:15], s64 offen offset:0 nt
buffer_load_dwordx4 v[56:59], v4, s[12:15], s64 offen offset:128 nt
buffer_load_dwordx4 v[60:63], v4, s[12:15], s64 offen offset:256 nt
s_add_u32 s64, s64, 98304
buffer_load_dwordx4 v[64:67], v4, s[12:15], s64 offen offset:0 nt
buffer_load_dwordx4 v[68:71], v4, s[12:15], s64 offen offset:128 nt
buffer_load_dwordx4 v[72:75], v4, s[12:15], s64 offen offset:256 nt
s_add_u32 s64, s64, 98304
buffer_load_dwordx4 v[76:79], v4, s[12:15], s64 offen offset:0 nt
buffer_load_dwordx4 v[80:83], v4, s[12:15], s64 offen offset:128 nt
buffer_load_dwordx4 v[84:87], v4, s[12:15], s64 offen offset:256 nt
s_add_u32 s64, s64, 98304
buffer_load_dwordx4 v[88:91], v4, s[12:15], s64 offen offset:0 nt
buffer_load_dwordx4 v[92:95], v4, s[12:15], s64 offen offset:128 nt
buffer_load_dwordx4 v[96:99], v4, s[12:15], s64 offen offset:256 nt
s_add_u32 s64, s64, 98304
buffer_load_dwordx4 v[100:103], v4, s[12:15], s64 offen offset:0 nt
buffer_load_dwordx4 v[104:107], v4, s[12:15], s64 offen offset:128 nt
buffer_load_dwordx4 v[108:111], v4, s[12:15], s64 offen offset:256 nt
s_add_u32 s64, s64, 98304
buffer_load_dwordx4 v[112:115], v4, s[12:15], s64 offen offset:0 nt
buffer_load_dwordx4 v[116:119], v4, s[12:15], s64 offen offset:128 nt
buffer_load_dwordx4 v[120:123], v4, s[12:15], s64 offen offset:256 nt
s_add_u32 s64, s64, 98304
buffer_load_dwordx4 v[124:127], v4, s[12:15], s64 offen offset:0 nt
buffer_load_dwordx4 v[128:131], v4, s[12:15], s64 offen offset:128 nt
buffer_load_dwordx4 v[132:135], v4, s[12:15], s64 offen offset:256 nt
s_add_u32 s64, s64, 98304
buffer_load_dwordx4 v[136:139], v4, s[12:15], s64 offen offset:0 nt
buffer_load_dwordx4 v[140:143], v4, s[12:15], s64 offen offset:128 nt
buffer_load_dwordx4 v[144:147], v4, s[12:15], s64 offen offset:256 nt
s_add_u32 s64, s64, 98304
buffer_load_dwordx4 v[148:151], v4, s[12:15], s64 offen offset:0 nt
buffer_load_dwordx4 v[152:155], v4, s[12:15], s64 offen offset:128 nt
buffer_load_dwordx4 v[156:159], v4, s[12:15], s64 offen offset:256 nt
v_mul_u32_u24 v4, 3072, v6
v_add_u32 v4, v4, v5
s_mul_i32 s64, s5, 245760
s_lshl_b32 s65, s4, 7
s_add_u32 s64, s64, s65
s_cmp_lt_u32 s4, 24
s_cselect_b32 s64, s64, 0x7ff00000
buffer_load_dwordx4 a[0:3], v4, s[24:27], s64 offen nt
buffer_load_dwordx4 a[4:7], v4, s[28:31], s64 offen nt
s_add_u32 s64, s64, 24576
buffer_load_dwordx4 a[8:11], v4, s[24:27], s64 offen nt
buffer_load_dwordx4 a[12:15], v4, s[28:31], s64 offen nt
s_add_u32 s64, s64, 24576
buffer_load_dwordx4 a[16:19], v4, s[24:27], s64 offen nt
buffer_load_dwordx4 a[20:23], v4, s[28:31], s64 offen nt
s_add_u32 s64, s64, 24576
buffer_load_dwordx4 a[24:27], v4, s[24:27], s64 offen nt
buffer_load_dwordx4 a[28:31], v4, s[28:31], s64 offen nt
s_add_u32 s64, s64, 24576
buffer_load_dwordx4 a[32:35], v4, s[24:27], s64 offen nt
buffer_load_dwordx4 a[36:39], v4, s[28:31], s64 offen nt
s_add_u32 s64, s64, 24576
buffer_load_dwordx4 a[40:43], v4, s[24:27], s64 offen nt
buffer_load_dwordx4 a[44:47], v4, s[28:31], s64 offen nt
s_add_u32 s64, s64, 24576
buffer_load_dwordx4 a[48:51], v4, s[24:27], s64 offen nt
buffer_load_dwordx4 a[52:55], v4, s[28:31], s64 offen nt
s_add_u32 s64, s64, 24576
buffer_load_dwordx4 a[56:59], v4, s[24:27], s64 offen nt
buffer_load_dwordx4 a[60:63], v4, s[28:31], s64 offen nt
s_add_u32 s64, s64, 24576
buffer_load_dwordx4 a[64:67], v4, s[24:27], s64 offen nt
buffer_load_dwordx4 a[68:71], v4, s[28:31], s64 offen nt
s_add_u32 s64, s64, 24576
buffer_load_dwordx4 a[72:75], v4, s[24:27], s64 offen nt
buffer_load_dwordx4 a[76:79], v4, s[28:31], s64 offen nt
s_barrier
s_mov_b32 s20, s48
s_and_b32 s21, s49, 0xffff
s_mov_b32 s22, 7864320
s_mov_b32 s23, 0x20000
s_mov_b32 s32, s56
s_and_b32 s33, s57, 0xffff
s_mov_b32 s34, 1966080
s_mov_b32 s35, 0x20000
s_mov_b32 s36, s58
s_and_b32 s37, s59, 0xffff
s_mov_b32 s38, 1280
s_mov_b32 s39, 0x20000
s_waitcnt vmcnt(50)
v_readfirstlane_b32 s66, v2
s_add_u32 s66, s66, 1
v_lshlrev_b32 v24, 16, v8
v_and_b32 v25, 0xffff0000, v8
v_lshlrev_b32 v26, 16, v9
v_and_b32 v27, 0xffff0000, v9
v_lshlrev_b32 v28, 16, v10
v_and_b32 v29, 0xffff0000, v10
v_lshlrev_b32 v30, 16, v11
v_and_b32 v31, 0xffff0000, v11
v_lshlrev_b32 v32, 16, v12
v_and_b32 v33, 0xffff0000, v12
v_add_f32 v14, v24, v25
v_add_f32 v14, v14, v26
v_add_f32 v14, v14, v27
v_add_f32 v14, v14, v28
v_add_f32 v14, v14, v29
v_add_f32 v14, v14, v30
v_add_f32 v14, v14, v31
v_add_f32 v14, v14, v32
v_add_f32 v14, v14, v33
s_nop 1
v_add_f32_dpp v14, v14, v14 quad_perm:[1,0,3,2] row_mask:0xf bank_mask:0xf
s_nop 1
v_add_f32_dpp v14, v14, v14 quad_perm:[2,3,0,1] row_mask:0xf bank_mask:0xf
s_nop 1
v_add_f32_dpp v14, v14, v14 row_half_mirror row_mask:0xf bank_mask:0xf
s_nop 1
v_add_f32_dpp v14, v14, v14 row_mirror row_mask:0xf bank_mask:0xf
s_nop 1
v_add_f32_dpp v14, v14, v14 row_bcast:15 row_mask:0xa bank_mask:0xf
s_nop 1
v_add_f32_dpp v14, v14, v14 row_bcast:31 row_mask:0xc bank_mask:0xf
s_nop 0
v_readlane_b32 s67, v14, 63
s_nop 1
v_mov_b32 v14, s67
v_mul_f32 v14, 0x3acccccd, v14
v_sub_f32 v15, v24, v14
v_mul_f32 v16, v15, v15
v_sub_f32 v15, v25, v14
v_fmac_f32 v16, v15, v15
v_sub_f32 v15, v26, v14
v_fmac_f32 v16, v15, v15
v_sub_f32 v15, v27, v14
v_fmac_f32 v16, v15, v15
v_sub_f32 v15, v28, v14
v_fmac_f32 v16, v15, v15
v_sub_f32 v15, v29, v14
v_fmac_f32 v16, v15, v15
v_sub_f32 v15, v30, v14
v_fmac_f32 v16, v15, v15
v_sub_f32 v15, v31, v14
v_fmac_f32 v16, v15, v15
v_sub_f32 v15, v32, v14
v_fmac_f32 v16, v15, v15
v_sub_f32 v15, v33, v14
v_fmac_f32 v16, v15, v15
s_nop 1
v_add_f32_dpp v16, v16, v16 quad_perm:[1,0,3,2] row_mask:0xf bank_mask:0xf
s_nop 1
v_add_f32_dpp v16, v16, v16 quad_perm:[2,3,0,1] row_mask:0xf bank_mask:0xf
s_nop 1
v_add_f32_dpp v16, v16, v16 row_half_mirror row_mask:0xf bank_mask:0xf
s_nop 1
v_add_f32_dpp v16, v16, v16 row_mirror row_mask:0xf bank_mask:0xf
s_nop 1
v_add_f32_dpp v16, v16, v16 row_bcast:15 row_mask:0xa bank_mask:0xf
s_nop 1
v_add_f32_dpp v16, v16, v16 row_bcast:31 row_mask:0xc bank_mask:0xf
s_nop 0
v_readlane_b32 s67, v16, 63
s_nop 1
v_mov_b32 v16, s67
v_mul_f32 v16, 0x3acccccd, v16
v_cvt_pk_bf16_f32 v16, v16, v16
v_and_b32 v16, 0xffff0000, v16
v_add_f32 v16, 0x3727c5ac, v16
v_cvt_pk_bf16_f32 v16, v16, v16
v_and_b32 v16, 0xffff0000, v16
v_sqrt_f32 v16, v16
s_nop 0
v_cvt_pk_bf16_f32 v16, v16, v16
v_and_b32 v16, 0xffff0000, v16
v_cvt_pk_bf16_f32 v14, v14, v14
v_and_b32 v14, 0xffff0000, v14
v_rcp_f32 v17, v16
v_lshlrev_b32 v18, 3, v0
v_sub_f32 v24, v24, v14
v_cvt_pk_bf16_f32 v24, v24, v24
v_and_b32 v24, 0xffff0000, v24
v_mul_f32 v15, v24, v17
v_fma_f32 v19, -v15, v16, v24
v_fma_f32 v15, v19, v17, v15
v_cvt_pk_bf16_f32 v24, v15, v15
v_sub_f32 v25, v25, v14
v_cvt_pk_bf16_f32 v25, v25, v25
v_and_b32 v25, 0xffff0000, v25
v_mul_f32 v15, v25, v17
v_fma_f32 v19, -v15, v16, v25
v_fma_f32 v15, v19, v17, v15
v_cvt_pk_bf16_f32 v25, v15, v15
ds_write_b64 v18, v[24:25] offset:1024
v_sub_f32 v26, v26, v14
v_cvt_pk_bf16_f32 v26, v26, v26
v_and_b32 v26, 0xffff0000, v26
v_mul_f32 v15, v26, v17
v_fma_f32 v19, -v15, v16, v26
v_fma_f32 v15, v19, v17, v15
v_cvt_pk_bf16_f32 v26, v15, v15
v_sub_f32 v27, v27, v14
v_cvt_pk_bf16_f32 v27, v27, v27
v_and_b32 v27, 0xffff0000, v27
v_mul_f32 v15, v27, v17
v_fma_f32 v19, -v15, v16, v27
v_fma_f32 v15, v19, v17, v15
v_cvt_pk_bf16_f32 v27, v15, v15
ds_write_b64 v18, v[26:27] offset:1536
v_sub_f32 v28, v28, v14
v_cvt_pk_bf16_f32 v28, v28, v28
v_and_b32 v28, 0xffff0000, v28
v_mul_f32 v15, v28, v17
v_fma_f32 v19, -v15, v16, v28
v_fma_f32 v15, v19, v17, v15
v_cvt_pk_bf16_f32 v28, v15, v15
v_sub_f32 v29, v29, v14
v_cvt_pk_bf16_f32 v29, v29, v29
v_and_b32 v29, 0xffff0000, v29
v_mul_f32 v15, v29, v17
v_fma_f32 v19, -v15, v16, v29
v_fma_f32 v15, v19, v17, v15
v_cvt_pk_bf16_f32 v29, v15, v15
ds_write_b64 v18, v[28:29] offset:2048
v_sub_f32 v30, v30, v14
v_cvt_pk_bf16_f32 v30, v30, v30
v_and_b32 v30, 0xffff0000, v30
v_mul_f32 v15, v30, v17
v_fma_f32 v19, -v15, v16, v30
v_fma_f32 v15, v19, v17, v15
v_cvt_pk_bf16_f32 v30, v15, v15
v_sub_f32 v31, v31, v14
v_cvt_pk_bf16_f32 v31, v31, v31
v_and_b32 v31, 0xffff0000, v31
v_mul_f32 v15, v31, v17
v_fma_f32 v19, -v15, v16, v31
v_fma_f32 v15, v19, v17, v15
v_cvt_pk_bf16_f32 v31, v15, v15
ds_write_b64 v18, v[30:31] offset:2560
v_sub_f32 v32, v32, v14
v_cvt_pk_bf16_f32 v32, v32, v32
v_and_b32 v32, 0xffff0000, v32
v_mul_f32 v15, v32, v17
v_fma_f32 v19, -v15, v16, v32
v_fma_f32 v15, v19, v17, v15
v_cvt_pk_bf16_f32 v32, v15, v15
v_sub_f32 v33, v33, v14
v_cvt_pk_bf16_f32 v33, v33, v33
v_and_b32 v33, 0xffff0000, v33
v_mul_f32 v15, v33, v17
v_fma_f32 v19, -v15, v16, v33
v_fma_f32 v15, v19, v17, v15
v_cvt_pk_bf16_f32 v33, v15, v15
ds_write_b64 v18, v[32:33] offset:3072
s_waitcnt lgkmcnt(0)
s_mul_i32 s67, s5, 320
v_lshlrev_b32 v18, 2, v6
v_add_u32 v18, s67, v18
ds_read_b32 v24, v18 offset:1024
ds_read_b32 v25, v18 offset:1056
ds_read_b32 v26, v18 offset:1088
ds_read_b32 v27, v18 offset:1120
ds_read_b32 v28, v18 offset:1152
ds_read_b32 v29, v18 offset:1184
ds_read_b32 v30, v18 offset:1216
ds_read_b32 v31, v18 offset:1248
ds_read_b32 v32, v18 offset:1280
ds_read_b32 v33, v18 offset:1312
v_mov_b32 v8, 0
v_mov_b32 v9, 0
v_mov_b32 v10, 0
v_mov_b32 v11, 0
v_mov_b32 v12, 0
v_mov_b32 v13, 0
v_mov_b32 v14, 0
v_mov_b32 v15, 0
v_mov_b32 v16, 0
v_mov_b32 v17, 0
v_mov_b32 v18, 0
v_mov_b32 v19, 0
v_lshlrev_b32 v38, 5, v7
v_bfe_u32 v39, v0, 4, 1
v_lshlrev_b32 v39, 4, v39
v_add_u32 v38, v38, v39
v_lshrrev_b32 v39, 5, v0
s_waitcnt lgkmcnt(0)
v_and_b32 v34, v24, v20
v_and_b32 v35, v24, v21
v_and_b32 v36, v24, v22
v_and_b32 v37, v24, v23
s_waitcnt vmcnt(47)
s_nop 0
v_mfma_f32_16x16x32_bf16 v[8:11], v[34:37], v[40:43], v[8:11]
v_mfma_f32_16x16x32_bf16 v[12:15], v[34:37], v[44:47], v[12:15]
v_mfma_f32_16x16x32_bf16 v[16:19], v[34:37], v[48:51], v[16:19]
v_and_b32 v2, v25, v20
v_and_b32 v3, v25, v21
v_and_b32 v4, v25, v22
v_and_b32 v5, v25, v23
s_waitcnt vmcnt(44)
s_nop 0
v_mfma_f32_16x16x32_bf16 v[8:11], v[2:5], v[52:55], v[8:11]
v_mfma_f32_16x16x32_bf16 v[12:15], v[2:5], v[56:59], v[12:15]
v_mfma_f32_16x16x32_bf16 v[16:19], v[2:5], v[60:63], v[16:19]
v_and_b32 v34, v26, v20
v_and_b32 v35, v26, v21
v_and_b32 v36, v26, v22
v_and_b32 v37, v26, v23
s_waitcnt vmcnt(41)
s_nop 0
v_mfma_f32_16x16x32_bf16 v[8:11], v[34:37], v[64:67], v[8:11]
v_mfma_f32_16x16x32_bf16 v[12:15], v[34:37], v[68:71], v[12:15]
v_mfma_f32_16x16x32_bf16 v[16:19], v[34:37], v[72:75], v[16:19]
v_and_b32 v2, v27, v20
v_and_b32 v3, v27, v21
v_and_b32 v4, v27, v22
v_and_b32 v5, v27, v23
s_waitcnt vmcnt(38)
s_nop 0
v_mfma_f32_16x16x32_bf16 v[8:11], v[2:5], v[76:79], v[8:11]
v_mfma_f32_16x16x32_bf16 v[12:15], v[2:5], v[80:83], v[12:15]
v_mfma_f32_16x16x32_bf16 v[16:19], v[2:5], v[84:87], v[16:19]
v_and_b32 v34, v28, v20
v_and_b32 v35, v28, v21
v_and_b32 v36, v28, v22
v_and_b32 v37, v28, v23
s_waitcnt vmcnt(35)
s_nop 0
v_mfma_f32_16x16x32_bf16 v[8:11], v[34:37], v[88:91], v[8:11]
v_mfma_f32_16x16x32_bf16 v[12:15], v[34:37], v[92:95], v[12:15]
v_mfma_f32_16x16x32_bf16 v[16:19], v[34:37], v[96:99], v[16:19]
v_and_b32 v2, v29, v20
v_and_b32 v3, v29, v21
v_and_b32 v4, v29, v22
v_and_b32 v5, v29, v23
s_waitcnt vmcnt(32)
s_nop 0
v_mfma_f32_16x16x32_bf16 v[8:11], v[2:5], v[100:103], v[8:11]
v_mfma_f32_16x16x32_bf16 v[12:15], v[2:5], v[104:107], v[12:15]
v_mfma_f32_16x16x32_bf16 v[16:19], v[2:5], v[108:111], v[16:19]
v_and_b32 v34, v30, v20
v_and_b32 v35, v30, v21
v_and_b32 v36, v30, v22
v_and_b32 v37, v30, v23
s_waitcnt vmcnt(29)
s_nop 0
v_mfma_f32_16x16x32_bf16 v[8:11], v[34:37], v[112:115], v[8:11]
v_mfma_f32_16x16x32_bf16 v[12:15], v[34:37], v[116:119], v[12:15]
v_mfma_f32_16x16x32_bf16 v[16:19], v[34:37], v[120:123], v[16:19]
v_and_b32 v2, v31, v20
v_and_b32 v3, v31, v21
v_and_b32 v4, v31, v22
v_and_b32 v5, v31, v23
s_waitcnt vmcnt(26)
s_nop 0
v_mfma_f32_16x16x32_bf16 v[8:11], v[2:5], v[124:127], v[8:11]
v_mfma_f32_16x16x32_bf16 v[12:15], v[2:5], v[128:131], v[12:15]
v_mfma_f32_16x16x32_bf16 v[16:19], v[2:5], v[132:135], v[16:19]
v_and_b32 v34, v32, v20
v_and_b32 v35, v32, v21
v_and_b32 v36, v32, v22
v_and_b32 v37, v32, v23
s_waitcnt vmcnt(23)
s_nop 0
v_mfma_f32_16x16x32_bf16 v[8:11], v[34:37], v[136:139], v[8:11]
v_mfma_f32_16x16x32_bf16 v[12:15], v[34:37], v[140:143], v[12:15]
v_mfma_f32_16x16x32_bf16 v[16:19], v[34:37], v[144:147], v[16:19]
v_and_b32 v2, v33, v20
v_and_b32 v3, v33, v21
v_and_b32 v4, v33, v22
v_and_b32 v5, v33, v23
s_waitcnt vmcnt(20)
s_nop 0
v_mfma_f32_16x16x32_bf16 v[8:11], v[2:5], v[148:151], v[8:11]
v_mfma_f32_16x16x32_bf16 v[12:15], v[2:5], v[152:155], v[12:15]
v_mfma_f32_16x16x32_bf16 v[16:19], v[2:5], v[156:159], v[16:19]
v_mul_u32_u24 v1, 768, v39
v_add_u32 v1, v1, v38
s_mov_b32 exec_lo, 0xff00ff
s_mov_b32 exec_hi, 0xff00ff00
s_nop 1
ds_write_b128 v1, v[8:11] offset:4608
ds_write_b128 v1, v[12:15] offset:4864
ds_write_b128 v1, v[16:19] offset:5120
s_mov_b64 exec, -1
v_mul_u32_u24 v2, 12, v0
v_add_u32 v3, 4608, v2
v_lshlrev_b32 v4, 4, v0
s_lshl_b32 s67, s2, 10
s_add_u32 s67, s67, 65536
s_waitcnt lgkmcnt(0)
ds_read2_b32 v[8:9], v3 offset0:0 offset1:192
ds_read2_b32 v[10:11], v3 offset0:1 offset1:193
ds_read2_b32 v[12:13], v3 offset0:2 offset1:194
s_waitcnt lgkmcnt(0)
v_add_f32 v16, v8, v9
v_add_f32 v17, v10, v11
v_add_f32 v18, v12, v13
v_mov_b32 v19, s66
buffer_store_dwordx4 v[16:19], v4, s[16:19], s67 offen sc1
s_waitcnt vmcnt(1)
v_mov_b32 v8, 0
v_mov_b32 v9, 0
v_mov_b32 v10, 0
v_mov_b32 v11, 0
v_mov_b32 v12, 0
v_mov_b32 v13, 0
v_mov_b32 v14, 0
v_mov_b32 v15, 0
v_and_b32 v34, v24, v20
v_and_b32 v35, v24, v21
v_and_b32 v36, v24, v22
v_and_b32 v37, v24, v23
s_nop 1
v_mfma_f32_16x16x32_bf16 v[8:11], v[34:37], a[0:3], v[8:11]
v_mfma_f32_16x16x32_bf16 v[12:15], v[34:37], a[4:7], v[12:15]
v_and_b32 v2, v25, v20
v_and_b32 v3, v25, v21
v_and_b32 v4, v25, v22
v_and_b32 v5, v25, v23
s_nop 1
v_mfma_f32_16x16x32_bf16 v[8:11], v[2:5], a[8:11], v[8:11]
v_mfma_f32_16x16x32_bf16 v[12:15], v[2:5], a[12:15], v[12:15]
v_and_b32 v34, v26, v20
v_and_b32 v35, v26, v21
v_and_b32 v36, v26, v22
v_and_b32 v37, v26, v23
s_nop 1
v_mfma_f32_16x16x32_bf16 v[8:11], v[34:37], a[16:19], v[8:11]
v_mfma_f32_16x16x32_bf16 v[12:15], v[34:37], a[20:23], v[12:15]
v_and_b32 v2, v27, v20
v_and_b32 v3, v27, v21
v_and_b32 v4, v27, v22
v_and_b32 v5, v27, v23
s_nop 1
v_mfma_f32_16x16x32_bf16 v[8:11], v[2:5], a[24:27], v[8:11]
v_mfma_f32_16x16x32_bf16 v[12:15], v[2:5], a[28:31], v[12:15]
v_and_b32 v34, v28, v20
v_and_b32 v35, v28, v21
v_and_b32 v36, v28, v22
v_and_b32 v37, v28, v23
s_nop 1
v_mfma_f32_16x16x32_bf16 v[8:11], v[34:37], a[32:35], v[8:11]
v_mfma_f32_16x16x32_bf16 v[12:15], v[34:37], a[36:39], v[12:15]
v_and_b32 v2, v29, v20
v_and_b32 v3, v29, v21
v_and_b32 v4, v29, v22
v_and_b32 v5, v29, v23
s_nop 1
v_mfma_f32_16x16x32_bf16 v[8:11], v[2:5], a[40:43], v[8:11]
v_mfma_f32_16x16x32_bf16 v[12:15], v[2:5], a[44:47], v[12:15]
v_and_b32 v34, v30, v20
v_and_b32 v35, v30, v21
v_and_b32 v36, v30, v22
v_and_b32 v37, v30, v23
s_nop 1
v_mfma_f32_16x16x32_bf16 v[8:11], v[34:37], a[48:51], v[8:11]
v_mfma_f32_16x16x32_bf16 v[12:15], v[34:37], a[52:55], v[12:15]
v_and_b32 v2, v31, v20
v_and_b32 v3, v31, v21
v_and_b32 v4, v31, v22
v_and_b32 v5, v31, v23
s_nop 1
v_mfma_f32_16x16x32_bf16 v[8:11], v[2:5], a[56:59], v[8:11]
v_mfma_f32_16x16x32_bf16 v[12:15], v[2:5], a[60:63], v[12:15]
v_and_b32 v34, v32, v20
v_and_b32 v35, v32, v21
v_and_b32 v36, v32, v22
v_and_b32 v37, v32, v23
s_nop 1
v_mfma_f32_16x16x32_bf16 v[8:11], v[34:37], a[64:67], v[8:11]
v_mfma_f32_16x16x32_bf16 v[12:15], v[34:37], a[68:71], v[12:15]
v_and_b32 v2, v33, v20
v_and_b32 v3, v33, v21
v_and_b32 v4, v33, v22
v_and_b32 v5, v33, v23
s_nop 1
v_mfma_f32_16x16x32_bf16 v[8:11], v[2:5], a[72:75], v[8:11]
v_mfma_f32_16x16x32_bf16 v[12:15], v[2:5], a[76:79], v[12:15]
v_lshlrev_b32 v1, 9, v39
v_add_u32 v1, v1, v38
s_mov_b32 exec_lo, 0xff00ff
s_mov_b32 exec_hi, 0xff00ff00
s_nop 2
ds_write_b128 v1, v[8:11] offset:6144
ds_write_b128 v1, v[12:15] offset:6400
s_mov_b64 exec, -1
s_cmp_ge_u32 s4, 24
s_cbranch_scc1 L_nogp
v_mul_u32_u24 v2, 12, v0
v_add_u32 v2, 6144, v2
v_lshlrev_b32 v4, 4, v0
s_waitcnt lgkmcnt(0)
ds_read2_b32 v[8:9], v2 offset0:0 offset1:128
ds_read2_b32 v[10:11], v2 offset0:1 offset1:129
ds_read2_b32 v[12:13], v2 offset0:2 offset1:130
s_waitcnt lgkmcnt(0)
v_add_f32 v16, v8, v9
v_add_f32 v17, v10, v11
v_add_f32 v18, v12, v13
v_mov_b32 v19, s66
s_lshl_b32 s67, s2, 10
s_add_u32 s67, s67, 1179648
s_mov_b32 exec_lo, -1
s_mov_b32 exec_hi, 0x7ff
buffer_store_dwordx4 v[16:19], v4, s[16:19], s67 offen sc1
s_mov_b64 exec, -1
L_nogp:
s_lshl_b32 s68, s4, 13
s_add_u32 s68, s68, 65536
v_lshlrev_b32 v4, 4, v0
s_mov_b32 s70, 200000
L_poll0:
s_add_u32 s69, s68, 0
buffer_load_dwordx4 v[40:43], v4, s[16:19], s69 offen sc1
s_add_u32 s69, s68, 1024
buffer_load_dwordx4 v[44:47], v4, s[16:19], s69 offen sc1
s_add_u32 s69, s68, 2048
buffer_load_dwordx4 v[48:51], v4, s[16:19], s69 offen sc1
s_add_u32 s69, s68, 3072
buffer_load_dwordx4 v[52:55], v4, s[16:19], s69 offen sc1
s_add_u32 s69, s68, 4096
buffer_load_dwordx4 v[56:59], v4, s[16:19], s69 offen sc1
s_add_u32 s69, s68, 5120
buffer_load_dwordx4 v[60:63], v4, s[16:19], s69 offen sc1
s_add_u32 s69, s68, 6144
buffer_load_dwordx4 v[64:67], v4, s[16:19], s69 offen sc1
s_add_u32 s69, s68, 7168
buffer_load_dwordx4 v[68:71], v4, s[16:19], s69 offen sc1
s_waitcnt vmcnt(0)
v_xor_b32 v5, s66, v43
v_xor_b32 v1, s66, v47
v_or_b32 v5, v5, v1
v_xor_b32 v1, s66, v51
v_or_b32 v5, v5, v1
v_xor_b32 v1, s66, v55
v_or_b32 v5, v5, v1
v_xor_b32 v1, s66, v59
v_or_b32 v5, v5, v1
v_xor_b32 v1, s66, v63
v_or_b32 v5, v5, v1
v_xor_b32 v1, s66, v67
v_or_b32 v5, v5, v1
v_xor_b32 v1, s66, v71
v_or_b32 v5, v5, v1
v_cmp_ne_u32 vcc, 0, v5
s_cbranch_vccz L_polld0
s_sub_u32 s70, s70, 1
s_cmp_eq_u32 s70, 0
s_cbranch_scc1 L_polld0
s_sleep 1
s_branch L_poll0
L_polld0:
v_add_f32 v8, v40, v44
v_add_f32 v8, v8, v48
v_add_f32 v8, v8, v52
v_add_f32 v8, v8, v56
v_add_f32 v8, v8, v60
v_add_f32 v8, v8, v64
v_add_f32 v8, v8, v68
v_add_f32 v9, v41, v45
v_add_f32 v9, v9, v49
v_add_f32 v9, v9, v53
v_add_f32 v9, v9, v57
v_add_f32 v9, v9, v61
v_add_f32 v9, v9, v65
v_add_f32 v9, v9, v69
v_add_f32 v10, v42, v46
v_add_f32 v10, v10, v50
v_add_f32 v10, v10, v54
v_add_f32 v10, v10, v58
v_add_f32 v10, v10, v62
v_add_f32 v10, v10, v66
v_add_f32 v10, v10, v70
v_cvt_pk_bf16_f32 v8, v8, v9
v_cvt_pk_bf16_f32 v10, v10, v10
v_mul_u32_u24 v2, 6, v0
ds_write_b16 v2, v8 offset:0
ds_write_b16_d16_hi v2, v8 offset:2
ds_write_b16 v2, v10 offset:4
s_waitcnt lgkmcnt(0)
s_barrier
s_cmp_ge_u32 s4, 24
s_cbranch_scc1 L_noB
s_cmp_ge_u32 s5, 5
s_cbranch_scc1 L_noB
v_mul_u32_u24 v4, 1280, v6
v_lshlrev_b32 v5, 4, v7
v_add_u32 v2, v4, v5
s_mul_i32 s67, s4, 81920
s_lshl_b32 s68, s5, 8
s_add_u32 s67, s67, s68
buffer_load_dwordx4 v[72:75], v2, s[32:35], s67 offen nt
buffer_load_dwordx4 v[104:107], v2, s[32:35], s67 offen offset:128 nt
s_add_u32 s67, s67, 10240
buffer_load_dwordx4 v[76:79], v2, s[32:35], s67 offen nt
buffer_load_dwordx4 v[108:111], v2, s[32:35], s67 offen offset:128 nt
s_add_u32 s67, s67, 10240
buffer_load_dwordx4 v[80:83], v2, s[32:35], s67 offen nt
buffer_load_dwordx4 v[112:115], v2, s[32:35], s67 offen offset:128 nt
s_add_u32 s67, s67, 10240
buffer_load_dwordx4 v[84:87], v2, s[32:35], s67 offen nt
buffer_load_dwordx4 v[116:119], v2, s[32:35], s67 offen offset:128 nt
s_add_u32 s67, s67, 10240
buffer_load_dwordx4 v[88:91], v2, s[32:35], s67 offen nt
buffer_load_dwordx4 v[120:123], v2, s[32:35], s67 offen offset:128 nt
s_add_u32 s67, s67, 10240
buffer_load_dwordx4 v[92:95], v2, s[32:35], s67 offen nt
buffer_load_dwordx4 v[124:127], v2, s[32:35], s67 offen offset:128 nt
s_add_u32 s67, s67, 10240
buffer_load_dwordx4 v[96:99], v2, s[32:35], s67 offen nt
buffer_load_dwordx4 v[128:131], v2, s[32:35], s67 offen offset:128 nt
s_add_u32 s67, s67, 10240
buffer_load_dwordx4 v[100:103], v2, s[32:35], s67 offen nt
buffer_load_dwordx4 v[132:135], v2, s[32:35], s67 offen offset:128 nt
v_lshlrev_b32 v4, 4, v0
s_lshl_b32 s68, s4, 13
s_add_u32 s68, s68, 1179648
s_mov_b32 exec_lo, -1
s_mov_b32 exec_hi, 0x7ff
s_mov_b32 s70, 200000
L_poll1:
s_add_u32 s69, s68, 0
buffer_load_dwordx4 v[40:43], v4, s[16:19], s69 offen sc1
s_add_u32 s69, s68, 1024
buffer_load_dwordx4 v[44:47], v4, s[16:19], s69 offen sc1
s_add_u32 s69, s68, 2048
buffer_load_dwordx4 v[48:51], v4, s[16:19], s69 offen sc1
s_add_u32 s69, s68, 3072
buffer_load_dwordx4 v[52:55], v4, s[16:19], s69 offen sc1
s_add_u32 s69, s68, 4096
buffer_load_dwordx4 v[56:59], v4, s[16:19], s69 offen sc1
s_add_u32 s69, s68, 5120
buffer_load_dwordx4 v[60:63], v4, s[16:19], s69 offen sc1
s_add_u32 s69, s68, 6144
buffer_load_dwordx4 v[64:67], v4, s[16:19], s69 offen sc1
s_add_u32 s69, s68, 7168
buffer_load_dwordx4 v[68:71], v4, s[16:19], s69 offen sc1
s_waitcnt vmcnt(0)
v_xor_b32 v5, s66, v43
v_xor_b32 v1, s66, v47
v_or_b32 v5, v5, v1
v_xor_b32 v1, s66, v51
v_or_b32 v5, v5, v1
v_xor_b32 v1, s66, v55
v_or_b32 v5, v5, v1
v_xor_b32 v1, s66, v59
v_or_b32 v5, v5, v1
v_xor_b32 v1, s66, v63
v_or_b32 v5, v5, v1
v_xor_b32 v1, s66, v67
v_or_b32 v5, v5, v1
v_xor_b32 v1, s66, v71
v_or_b32 v5, v5, v1
v_cmp_ne_u32 vcc, 0, v5
s_cbranch_vccz L_polld1
s_sub_u32 s70, s70, 1
s_cmp_eq_u32 s70, 0
s_cbranch_scc1 L_polld1
s_sleep 8
s_branch L_poll1
L_polld1:
v_add_f32 v8, v40, v44
v_add_f32 v8, v8, v48
v_add_f32 v8, v8, v52
v_add_f32 v8, v8, v56
v_add_f32 v8, v8, v60
v_add_f32 v8, v8, v64
v_add_f32 v8, v8, v68
v_add_f32 v9, v41, v45
v_add_f32 v9, v9, v49
v_add_f32 v9, v9, v53
v_add_f32 v9, v9, v57
v_add_f32 v9, v9, v61
v_add_f32 v9, v9, v65
v_add_f32 v9, v9, v69
v_add_f32 v10, v42, v46
v_add_f32 v10, v10, v50
v_add_f32 v10, v10, v54
v_add_f32 v10, v10, v58
v_add_f32 v10, v10, v62
v_add_f32 v10, v10, v66
v_add_f32 v10, v10, v70
v_mul_u32_u24 v2, 12, v0
v_add_u32 v2, 4608, v2
ds_write2_b32 v2, v8, v9 offset0:0 offset1:1
ds_write_b32 v2, v10 offset:8
s_mov_b64 exec, -1
v_lshlrev_b32 v2, 2, v0
v_add_u32 v3, 4608, v2
s_waitcnt lgkmcnt(0)
ds_read2_b32 v[8:9], v3 offset0:0 offset1:64
s_waitcnt lgkmcnt(0)
v_cvt_pk_bf16_f32 v8, v8, v8
v_and_b32 v8, 0xffff0000, v8
v_cvt_pk_bf16_f32 v9, v9, v9
v_and_b32 v9, 0xffff0000, v9
v_max_f32 v8, 0, v8
v_mul_f32 v8, v8, v9
v_cvt_pk_bf16_f32 v8, v8, v8
ds_write_b32 v2, v8 offset:4352
v_lshlrev_b32 v18, 2, v6
s_waitcnt lgkmcnt(0)
ds_read_b32 v24, v18 offset:4352
ds_read_b32 v25, v18 offset:4384
ds_read_b32 v26, v18 offset:4416
ds_read_b32 v27, v18 offset:4448
ds_read_b32 v28, v18 offset:4480
ds_read_b32 v29, v18 offset:4512
ds_read_b32 v30, v18 offset:4544
ds_read_b32 v31, v18 offset:4576
v_mov_b32 v8, 0
v_mov_b32 v9, 0
v_mov_b32 v10, 0
v_mov_b32 v11, 0
v_mov_b32 v12, 0
v_mov_b32 v13, 0
v_mov_b32 v14, 0
v_mov_b32 v15, 0
s_waitcnt vmcnt(0) lgkmcnt(0)
v_and_b32 v16, v24, v20
v_and_b32 v17, v24, v21
v_and_b32 v18, v24, v22
v_and_b32 v19, v24, v23
s_nop 1
v_mfma_f32_16x16x32_bf16 v[8:11], v[16:19], v[72:75], v[8:11]
v_mfma_f32_16x16x32_bf16 v[12:15], v[16:19], v[104:107], v[12:15]
v_and_b32 v2, v25, v20
v_and_b32 v3, v25, v21
v_and_b32 v4, v25, v22
v_and_b32 v5, v25, v23
s_nop 1
v_mfma_f32_16x16x32_bf16 v[8:11], v[2:5], v[76:79], v[8:11]
v_mfma_f32_16x16x32_bf16 v[12:15], v[2:5], v[108:111], v[12:15]
v_and_b32 v16, v26, v20
v_and_b32 v17, v26, v21
v_and_b32 v18, v26, v22
v_and_b32 v19, v26, v23
s_nop 1
v_mfma_f32_16x16x32_bf16 v[8:11], v[16:19], v[80:83], v[8:11]
v_mfma_f32_16x16x32_bf16 v[12:15], v[16:19], v[112:115], v[12:15]
v_and_b32 v2, v27, v20
v_and_b32 v3, v27, v21
v_and_b32 v4, v27, v22
v_and_b32 v5, v27, v23
s_nop 1
v_mfma_f32_16x16x32_bf16 v[8:11], v[2:5], v[84:87], v[8:11]
v_mfma_f32_16x16x32_bf16 v[12:15], v[2:5], v[116:119], v[12:15]
v_and_b32 v16, v28, v20
v_and_b32 v17, v28, v21
v_and_b32 v18, v28, v22
v_and_b32 v19, v28, v23
s_nop 1
v_mfma_f32_16x16x32_bf16 v[8:11], v[16:19], v[88:91], v[8:11]
v_mfma_f32_16x16x32_bf16 v[12:15], v[16:19], v[120:123], v[12:15]
v_and_b32 v2, v29, v20
v_and_b32 v3, v29, v21
v_and_b32 v4, v29, v22
v_and_b32 v5, v29, v23
s_nop 1
v_mfma_f32_16x16x32_bf16 v[8:11], v[2:5], v[92:95], v[8:11]
v_mfma_f32_16x16x32_bf16 v[12:15], v[2:5], v[124:127], v[12:15]
v_and_b32 v16, v30, v20
v_and_b32 v17, v30, v21
v_and_b32 v18, v30, v22
v_and_b32 v19, v30, v23
s_nop 1
v_mfma_f32_16x16x32_bf16 v[8:11], v[16:19], v[96:99], v[8:11]
v_mfma_f32_16x16x32_bf16 v[12:15], v[16:19], v[128:131], v[12:15]
v_and_b32 v2, v31, v20
v_and_b32 v3, v31, v21
v_and_b32 v4, v31, v22
v_and_b32 v5, v31, v23
s_nop 1
v_mfma_f32_16x16x32_bf16 v[8:11], v[2:5], v[100:103], v[8:11]
v_mfma_f32_16x16x32_bf16 v[12:15], v[2:5], v[132:135], v[12:15]
v_cmp_lt_u32 vcc, 21, v0
s_nop 1
v_cndmask_b32 v34, 0, 1, vcc
v_mul_u32_u24 v35, 22, v34
v_sub_u32 v35, v0, v35
v_lshlrev_b32 v1, 9, v39
v_add_u32 v1, v1, v38
s_mov_b32 exec_lo, 0xff00ff
s_mov_b32 exec_hi, 0xff00ff00
ds_write_b128 v1, v[8:11] offset:4608
ds_write_b128 v1, v[12:15] offset:4864
s_mov_b64 exec, -1
v_lshlrev_b32 v2, 8, v34
v_mul_u32_u24 v3, 12, v35
v_add_u32 v2, v2, v3
v_add_u32 v2, 4608, v2
v_mul_u32_u24 v4, 12288, v34
v_lshlrev_b32 v3, 4, v35
v_add_u32 v4, v4, v3
s_mul_i32 s67, s5, 48
s_add_u32 s67, s67, s4
s_lshl_b32 s67, s67, 9
s_add_u32 s67, s67, 1048576
s_waitcnt lgkmcnt(0)
ds_read2_b32 v[8:9], v2 offset0:0 offset1:128
ds_read2_b32 v[10:11], v2 offset0:1 offset1:129
ds_read2_b32 v[12:13], v2 offset0:2 offset1:130
s_waitcnt lgkmcnt(0)
v_add_f32 v16, v8, v9
v_add_f32 v17, v10, v11
v_add_f32 v18, v12, v13
v_mov_b32 v19, s66
s_mov_b32 exec_lo, -1
s_mov_b32 exec_hi, 0xfff
buffer_store_dwordx4 v[16:19], v4, s[16:19], s67 offen sc1
s_mov_b64 exec, -1
L_noB:
v_cmp_lt_u32 vcc, 21, v0
s_nop 1
v_cndmask_b32 v34, 0, 1, vcc
v_mul_u32_u24 v35, 22, v34
v_sub_u32 v35, v0, v35
s_cmp_ge_u32 s5, 5
s_cbranch_scc1 L_nowo
v_mul_u32_u24 v4, 1280, v6
v_lshlrev_b32 v5, 4, v7
v_add_u32 v2, v4, v5
s_mul_i32 s67, s4, 245760
s_lshl_b32 s68, s5, 8
s_add_u32 s67, s67, s68
s_add_u32 s67, s67, 163840
buffer_load_dwordx4 v[40:43], v2, s[20:23], s67 offen nt
buffer_load_dwordx4 v[72:75], v2, s[20:23], s67 offen offset:128 nt
s_add_u32 s67, s67, 10240
buffer_load_dwordx4 v[44:47], v2, s[20:23], s67 offen nt
buffer_load_dwordx4 v[76:79], v2, s[20:23], s67 offen offset:128 nt
s_add_u32 s67, s67, 10240
buffer_load_dwordx4 v[48:51], v2, s[20:23], s67 offen nt
buffer_load_dwordx4 v[80:83], v2, s[20:23], s67 offen offset:128 nt
s_add_u32 s67, s67, 10240
buffer_load_dwordx4 v[52:55], v2, s[20:23], s67 offen nt
buffer_load_dwordx4 v[84:87], v2, s[20:23], s67 offen offset:128 nt
s_add_u32 s67, s67, 10240
buffer_load_dwordx4 v[56:59], v2, s[20:23], s67 offen nt
buffer_load_dwordx4 v[88:91], v2, s[20:23], s67 offen offset:128 nt
s_add_u32 s67, s67, 10240
buffer_load_dwordx4 v[60:63], v2, s[20:23], s67 offen nt
buffer_load_dwordx4 v[92:95], v2, s[20:23], s67 offen offset:128 nt
s_add_u32 s67, s67, 10240
buffer_load_dwordx4 v[64:67], v2, s[20:23], s67 offen nt
buffer_load_dwordx4 v[96:99], v2, s[20:23], s67 offen offset:128 nt
s_add_u32 s67, s67, 10240
buffer_load_dwordx4 v[68:71], v2, s[20:23], s67 offen nt
buffer_load_dwordx4 v[100:103], v2, s[20:23], s67 offen offset:128 nt
L_nowo:
s_sub_u32 s71, s5, 5
s_lshl_b32 s71, s71, 3
s_add_u32 s71, s71, s4
s_sub_u32 s71, s71, 24
s_cmp_lt_u32 s4, 24
s_cselect_b32 s71, -1, s71
s_cmp_lt_u32 s5, 5
s_cselect_b32 s71, -1, s71
s_cmp_lt_u32 s71, 10
s_cselect_b32 s71, s71, -1
s_waitcnt vmcnt(0)
s_cmp_ge_u32 s5, 5
s_cbranch_scc1 L_nofr
v_mov_b32 v120, 0
v_mov_b32 v121, 0
v_mov_b32 v122, 0
v_mov_b32 v123, 0
v_mov_b32 v124, 0
v_mov_b32 v125, 0
v_mov_b32 v126, 0
v_mov_b32 v127, 0
s_waitcnt lgkmcnt(0)
L_nofr:
s_barrier
v_mul_u32_u24 v2, 12, v0
v_add_u32 v2, 9728, v2
v_mov_b32 v3, 512
ds_read_b128 v[8:11], v3
ds_read2_b32 v[136:137], v2 offset0:0 offset1:192
ds_read2_b32 v[138:139], v2 offset0:1 offset1:193
ds_read2_b32 v[140:141], v2 offset0:2 offset1:194
v_add_u32 v2, 1536, v2
ds_read2_b32 v[142:143], v2 offset0:0 offset1:192
ds_read2_b32 v[144:145], v2 offset0:1 offset1:193
ds_read2_b32 v[146:147], v2 offset0:2 offset1:194
s_waitcnt lgkmcnt(6)
v_max_f32 v16, v8, v10
v_sub_f32 v8, v8, v16
v_mul_f32 v8, 0x3fb8aa3b, v8
v_exp_f32 v8, v8
v_sub_f32 v10, v10, v16
v_mul_f32 v10, 0x3fb8aa3b, v10
v_exp_f32 v10, v10
v_mul_f32 v17, v8, v9
v_fmac_f32 v17, v10, v11
s_waitcnt lgkmcnt(0)
v_add_f32 v136, v136, v137
v_mul_f32 v24, v136, v8
v_add_f32 v142, v142, v143
v_fmac_f32 v24, v142, v10
v_add_f32 v138, v138, v139
v_mul_f32 v25, v138, v8
v_add_f32 v144, v144, v145
v_fmac_f32 v25, v144, v10
v_add_f32 v140, v140, v141
v_mul_f32 v26, v140, v8
v_add_f32 v146, v146, v147
v_fmac_f32 v26, v146, v10
v_mov_b32 v27, s66
v_lshlrev_b32 v4, 4, v0
s_lshl_b32 s67, s2, 11
s_add_u32 s67, s67, 327680
buffer_store_dwordx4 v[24:27], v4, s[16:19], s67 offen sc1
v_mov_b32 v18, 0
v_mov_b32 v19, s66
s_mov_b64 exec, 1
v_mov_b32 v5, 0
buffer_store_dwordx4 v[16:19], v5, s[16:19], s67 offen offset:1024 sc1
s_mov_b64 exec, -1
s_cmp_ge_u32 s5, 5
s_cbranch_scc1 L_t5
s_lshl_b32 s68, s4, 14
s_add_u32 s68, s68, 327680
v_and_b32 v5, 7, v0
v_lshlrev_b32 v5, 11, v5
v_add_u32 v3, 1024, v5
s_mov_b32 s70, 200000
buffer_load_dwordx4 v[160:163], v3, s[16:19], s68 offen sc1
s_add_u32 s69, s68, 0
buffer_load_dwordx4 v[164:167], v4, s[16:19], s69 offen sc1
s_add_u32 s69, s68, 2048
buffer_load_dwordx4 v[168:171], v4, s[16:19], s69 offen sc1
s_add_u32 s69, s68, 4096
buffer_load_dwordx4 v[172:175], v4, s[16:19], s69 offen sc1
s_add_u32 s69, s68, 6144
buffer_load_dwordx4 v[176:179], v4, s[16:19], s69 offen sc1
s_add_u32 s69, s68, 8192
buffer_load_dwordx4 v[180:183], v4, s[16:19], s69 offen sc1
s_add_u32 s69, s68, 10240
buffer_load_dwordx4 v[184:187], v4, s[16:19], s69 offen sc1
s_add_u32 s69, s68, 12288
buffer_load_dwordx4 v[188:191], v4, s[16:19], s69 offen sc1
s_add_u32 s69, s68, 14336
buffer_load_dwordx4 v[192:195], v4, s[16:19], s69 offen sc1
L_poll2:
s_sleep 2
buffer_load_dwordx4 v[196:199], v3, s[16:19], s68 offen sc1
s_add_u32 s69, s68, 0
buffer_load_dwordx4 v[200:203], v4, s[16:19], s69 offen sc1
s_add_u32 s69, s68, 2048
buffer_load_dwordx4 v[204:207], v4, s[16:19], s69 offen sc1
s_add_u32 s69, s68, 4096
buffer_load_dwordx4 v[208:211], v4, s[16:19], s69 offen sc1
s_add_u32 s69, s68, 6144
buffer_load_dwordx4 v[212:215], v4, s[16:19], s69 offen sc1
s_add_u32 s69, s68, 8192
buffer_load_dwordx4 v[216:219], v4, s[16:19], s69 offen sc1
s_add_u32 s69, s68, 10240
buffer_load_dwordx4 v[220:223], v4, s[16:19], s69 offen sc1
s_add_u32 s69, s68, 12288
buffer_load_dwordx4 v[224:227], v4, s[16:19], s69 offen sc1
s_add_u32 s69, s68, 14336
buffer_load_dwordx4 v[228:231], v4, s[16:19], s69 offen sc1
s_waitcnt vmcnt(9)
v_xor_b32 v5, s66, v163
v_xor_b32 v1, s66, v167
v_or_b32 v5, v5, v1
v_xor_b32 v1, s66, v171
v_or_b32 v5, v5, v1
v_xor_b32 v1, s66, v175
v_or_b32 v5, v5, v1
v_xor_b32 v1, s66, v179
v_or_b32 v5, v5, v1
v_xor_b32 v1, s66, v183
v_or_b32 v5, v5, v1
v_xor_b32 v1, s66, v187
v_or_b32 v5, v5, v1
v_xor_b32 v1, s66, v191
v_or_b32 v5, v5, v1
v_xor_b32 v1, s66, v195
v_or_b32 v5, v5, v1
v_cmp_ne_u32 vcc, 0, v5
s_cbranch_vccz L_pollA2
s_sub_u32 s70, s70, 1
s_cmp_eq_u32 s70, 0
s_cbranch_scc1 L_pollA2
s_sleep 2
buffer_load_dwordx4 v[160:163], v3, s[16:19], s68 offen sc1
s_add_u32 s69, s68, 0
buffer_load_dwordx4 v[164:167], v4, s[16:19], s69 offen sc1
s_add_u32 s69, s68, 2048
buffer_load_dwordx4 v[168:171], v4, s[16:19], s69 offen sc1
s_add_u32 s69, s68, 4096
buffer_load_dwordx4 v[172:175], v4, s[16:19], s69 offen sc1
s_add_u32 s69, s68, 6144
buffer_load_dwordx4 v[176:179], v4, s[16:19], s69 offen sc1
s_add_u32 s69, s68, 8192
buffer_load_dwordx4 v[180:183], v4, s[16:19], s69 offen sc1
s_add_u32 s69, s68, 10240
buffer_load_dwordx4 v[184:187], v4, s[16:19], s69 offen sc1
s_add_u32 s69, s68, 12288
buffer_load_dwordx4 v[188:191], v4, s[16:19], s69 offen sc1
s_add_u32 s69, s68, 14336
buffer_load_dwordx4 v[192:195], v4, s[16:19], s69 offen sc1
s_waitcnt vmcnt(9)
v_xor_b32 v5, s66, v199
v_xor_b32 v1, s66, v203
v_or_b32 v5, v5, v1
v_xor_b32 v1, s66, v207
v_or_b32 v5, v5, v1
v_xor_b32 v1, s66, v211
v_or_b32 v5, v5, v1
v_xor_b32 v1, s66, v215
v_or_b32 v5, v5, v1
v_xor_b32 v1, s66, v219
v_or_b32 v5, v5, v1
v_xor_b32 v1, s66, v223
v_or_b32 v5, v5, v1
v_xor_b32 v1, s66, v227
v_or_b32 v5, v5, v1
v_xor_b32 v1, s66, v231
v_or_b32 v5, v5, v1
v_cmp_ne_u32 vcc, 0, v5
s_cbranch_vccz L_pollB2
s_sub_u32 s70, s70, 1
s_cmp_eq_u32 s70, 0
s_cbranch_scc1 L_pollB2
s_branch L_poll2
L_pollB2:
v_mov_b32 v10, v196
s_nop 1
v_max_f32_dpp v10, v10, v10 quad_perm:[1,0,3,2] row_mask:0xf bank_mask:0xf
s_nop 1
v_max_f32_dpp v10, v10, v10 quad_perm:[2,3,0,1] row_mask:0xf bank_mask:0xf
s_nop 1
v_max_f32_dpp v10, v10, v10 row_half_mirror row_mask:0xf bank_mask:0xf
v_sub_f32 v8, v196, v10
v_mul_f32 v8, 0x3fb8aa3b, v8
v_exp_f32 v8, v8
s_nop 0
v_mul_f32 v9, v8, v197
s_nop 1
v_add_f32_dpp v9, v9, v9 quad_perm:[1,0,3,2] row_mask:0xf bank_mask:0xf
s_nop 1
v_add_f32_dpp v9, v9, v9 quad_perm:[2,3,0,1] row_mask:0xf bank_mask:0xf
s_nop 1
v_add_f32_dpp v9, v9, v9 row_half_mirror row_mask:0xf bank_mask:0xf
v_rcp_f32 v10, v9
s_nop 0
v_mul_f32 v11, v8, v10
v_fma_f32 v5, -v11, v9, v8
v_fma_f32 v8, v5, v10, v11
s_nop 0
v_readlane_b32 s76, v8, 0
v_readlane_b32 s77, v8, 1
v_readlane_b32 s78, v8, 2
v_readlane_b32 s79, v8, 3
v_readlane_b32 s80, v8, 4
v_readlane_b32 s81, v8, 5
v_readlane_b32 s82, v8, 6
v_readlane_b32 s83, v8, 7
v_mul_f32 v24, s76, v200
v_mul_f32 v25, s76, v201
v_mul_f32 v26, s76, v202
v_fmac_f32 v24, s77, v204
v_fmac_f32 v25, s77, v205
v_fmac_f32 v26, s77, v206
v_fmac_f32 v24, s78, v208
v_fmac_f32 v25, s78, v209
v_fmac_f32 v26, s78, v210
v_fmac_f32 v24, s79, v212
v_fmac_f32 v25, s79, v213
v_fmac_f32 v26, s79, v214
v_fmac_f32 v24, s80, v216
v_fmac_f32 v25, s80, v217
v_fmac_f32 v26, s80, v218
v_fmac_f32 v24, s81, v220
v_fmac_f32 v25, s81, v221
v_fmac_f32 v26, s81, v222
v_fmac_f32 v24, s82, v224
v_fmac_f32 v25, s82, v225
v_fmac_f32 v26, s82, v226
v_fmac_f32 v24, s83, v228
v_fmac_f32 v25, s83, v229
v_fmac_f32 v26, s83, v230
s_branch L_polld2
L_pollA2:
v_mov_b32 v10, v160
s_nop 1
v_max_f32_dpp v10, v10, v10 quad_perm:[1,0,3,2] row_mask:0xf bank_mask:0xf
s_nop 1
v_max_f32_dpp v10, v10, v10 quad_perm:[2,3,0,1] row_mask:0xf bank_mask:0xf
s_nop 1
v_max_f32_dpp v10, v10, v10 row_half_mirror row_mask:0xf bank_mask:0xf
v_sub_f32 v8, v160, v10
v_mul_f32 v8, 0x3fb8aa3b, v8
v_exp_f32 v8, v8
s_nop 0
v_mul_f32 v9, v8, v161
s_nop 1
v_add_f32_dpp v9, v9, v9 quad_perm:[1,0,3,2] row_mask:0xf bank_mask:0xf
s_nop 1
v_add_f32_dpp v9, v9, v9 quad_perm:[2,3,0,1] row_mask:0xf bank_mask:0xf
s_nop 1
v_add_f32_dpp v9, v9, v9 row_half_mirror row_mask:0xf bank_mask:0xf
v_rcp_f32 v10, v9
s_nop 0
v_mul_f32 v11, v8, v10
v_fma_f32 v5, -v11, v9, v8
v_fma_f32 v8, v5, v10, v11
s_nop 0
v_readlane_b32 s76, v8, 0
v_readlane_b32 s77, v8, 1
v_readlane_b32 s78, v8, 2
v_readlane_b32 s79, v8, 3
v_readlane_b32 s80, v8, 4
v_readlane_b32 s81, v8, 5
v_readlane_b32 s82, v8, 6
v_readlane_b32 s83, v8, 7
v_mul_f32 v24, s76, v164
v_mul_f32 v25, s76, v165
v_mul_f32 v26, s76, v166
v_fmac_f32 v24, s77, v168
v_fmac_f32 v25, s77, v169
v_fmac_f32 v26, s77, v170
v_fmac_f32 v24, s78, v172
v_fmac_f32 v25, s78, v173
v_fmac_f32 v26, s78, v174
v_fmac_f32 v24, s79, v176
v_fmac_f32 v25, s79, v177
v_fmac_f32 v26, s79, v178
v_fmac_f32 v24, s80, v180
v_fmac_f32 v25, s80, v181
v_fmac_f32 v26, s80, v182
v_fmac_f32 v24, s81, v184
v_fmac_f32 v25, s81, v185
v_fmac_f32 v26, s81, v186
v_fmac_f32 v24, s82, v188
v_fmac_f32 v25, s82, v189
v_fmac_f32 v26, s82, v190
v_fmac_f32 v24, s83, v192
v_fmac_f32 v25, s83, v193
v_fmac_f32 v26, s83, v194
L_polld2:
v_mul_u32_u24 v2, 12, v0
v_cvt_pk_bf16_f32 v24, v24, v24
v_cvt_pk_bf16_f32 v25, v25, v25
v_cvt_pk_bf16_f32 v26, v26, v26
v_add_u32 v2, 3584, v2
ds_write2_b32 v2, v24, v25 offset0:0 offset1:1
ds_write_b32 v2, v26 offset:8
v_lshlrev_b32 v2, 8, v34
v_mul_u32_u24 v3, 12, v35
v_add_u32 v2, v2, v3
v_add_u32 v2, 9728, v2
v_mul_u32_u24 v4, 16384, v34
v_lshlrev_b32 v3, 4, v35
v_add_u32 v4, v4, v3
s_lshl_b32 s67, s5, 6
s_add_u32 s67, s67, s4
s_lshl_b32 s67, s67, 9
s_add_u32 s67, s67, 851968
v_lshlrev_b32 v18, 2, v6
v_add_u32 v18, 512, v18
v_lshlrev_b32 v1, 9, v39
v_add_u32 v1, v1, v38
v_add_u32 v1, 11776, v1
s_waitcnt lgkmcnt(0)
s_barrier
ds_read_b32 v104, v18 offset:3584
ds_read_b32 v105, v18 offset:3616
ds_read_b32 v106, v18 offset:3648
ds_read_b32 v107, v18 offset:3680
ds_read_b32 v108, v18 offset:3712
ds_read_b32 v109, v18 offset:3744
ds_read_b32 v110, v18 offset:3776
ds_read_b32 v111, v18 offset:3808
s_waitcnt lgkmcnt(6)
v_and_b32 v112, v104, v20
v_and_b32 v113, v104, v21
v_and_b32 v114, v104, v22
v_and_b32 v115, v104, v23
s_nop 1
v_mfma_f32_16x16x32_bf16 v[120:123], v[112:115], v[40:43], v[120:123]
v_mfma_f32_16x16x32_bf16 v[124:127], v[112:115], v[72:75], v[124:127]
v_and_b32 v116, v105, v20
v_and_b32 v117, v105, v21
v_and_b32 v118, v105, v22
v_and_b32 v119, v105, v23
s_nop 1
v_mfma_f32_16x16x32_bf16 v[120:123], v[116:119], v[44:47], v[120:123]
v_mfma_f32_16x16x32_bf16 v[124:127], v[116:119], v[76:79], v[124:127]
s_waitcnt lgkmcnt(4)
v_and_b32 v112, v106, v20
v_and_b32 v113, v106, v21
v_and_b32 v114, v106, v22
v_and_b32 v115, v106, v23
s_nop 1
v_mfma_f32_16x16x32_bf16 v[120:123], v[112:115], v[48:51], v[120:123]
v_mfma_f32_16x16x32_bf16 v[124:127], v[112:115], v[80:83], v[124:127]
v_and_b32 v116, v107, v20
v_and_b32 v117, v107, v21
v_and_b32 v118, v107, v22
v_and_b32 v119, v107, v23
s_nop 1
v_mfma_f32_16x16x32_bf16 v[120:123], v[116:119], v[52:55], v[120:123]
v_mfma_f32_16x16x32_bf16 v[124:127], v[116:119], v[84:87], v[124:127]
s_waitcnt lgkmcnt(2)
v_and_b32 v112, v108, v20
v_and_b32 v113, v108, v21
v_and_b32 v114, v108, v22
v_and_b32 v115, v108, v23
s_nop 1
v_mfma_f32_16x16x32_bf16 v[120:123], v[112:115], v[56:59], v[120:123]
v_mfma_f32_16x16x32_bf16 v[124:127], v[112:115], v[88:91], v[124:127]
v_and_b32 v116, v109, v20
v_and_b32 v117, v109, v21
v_and_b32 v118, v109, v22
v_and_b32 v119, v109, v23
s_nop 1
v_mfma_f32_16x16x32_bf16 v[120:123], v[116:119], v[60:63], v[120:123]
v_mfma_f32_16x16x32_bf16 v[124:127], v[116:119], v[92:95], v[124:127]
s_waitcnt lgkmcnt(0)
v_and_b32 v112, v110, v20
v_and_b32 v113, v110, v21
v_and_b32 v114, v110, v22
v_and_b32 v115, v110, v23
s_nop 1
v_mfma_f32_16x16x32_bf16 v[120:123], v[112:115], v[64:67], v[120:123]
v_mfma_f32_16x16x32_bf16 v[124:127], v[112:115], v[96:99], v[124:127]
v_and_b32 v116, v111, v20
v_and_b32 v117, v111, v21
v_and_b32 v118, v111, v22
v_and_b32 v119, v111, v23
s_nop 1
v_mfma_f32_16x16x32_bf16 v[120:123], v[116:119], v[68:71], v[120:123]
v_mfma_f32_16x16x32_bf16 v[124:127], v[116:119], v[100:103], v[124:127]
s_mov_b32 exec_lo, 0xff00ff
s_mov_b32 exec_hi, 0xff00ff00
s_nop 4
ds_write_b128 v1, v[120:123]
ds_write_b128 v1, v[124:127] offset:256
s_mov_b64 exec, -1
s_waitcnt lgkmcnt(0)
s_barrier
ds_read2_b32 v[136:137], v2 offset0:0 offset1:128
ds_read2_b32 v[138:139], v2 offset0:1 offset1:129
ds_read2_b32 v[140:141], v2 offset0:2 offset1:130
v_add_u32 v2, 1024, v2
ds_read2_b32 v[142:143], v2 offset0:0 offset1:128
ds_read2_b32 v[144:145], v2 offset0:1 offset1:129
ds_read2_b32 v[146:147], v2 offset0:2 offset1:130
v_add_u32 v2, 1024, v2
ds_read2_b32 v[148:149], v2 offset0:0 offset1:128
ds_read2_b32 v[150:151], v2 offset0:1 offset1:129
ds_read2_b32 v[152:153], v2 offset0:2 offset1:130
s_waitcnt lgkmcnt(0)
v_add_f32 v136, v136, v137
v_add_f32 v142, v142, v143
v_add_f32 v148, v148, v149
v_add_f32 v136, v136, v142
v_add_f32 v16, v136, v148
v_add_f32 v138, v138, v139
v_add_f32 v144, v144, v145
v_add_f32 v150, v150, v151
v_add_f32 v138, v138, v144
v_add_f32 v17, v138, v150
v_add_f32 v140, v140, v141
v_add_f32 v146, v146, v147
v_add_f32 v152, v152, v153
v_add_f32 v140, v140, v146
v_add_f32 v18, v140, v152
v_mov_b32 v19, s66
s_mov_b32 exec_lo, -1
s_mov_b32 exec_hi, 0xfff
buffer_store_dwordx4 v[16:19], v4, s[16:19], s67 offen sc1
s_mov_b64 exec, -1
s_branch L_fin
L_t5:
s_cmp_eq_u32 s71, -1
s_cbranch_scc1 L_fin
v_lshlrev_b32 v2, 9, v34
v_lshlrev_b32 v3, 4, v35
v_add_u32 v2, v2, v3
s_mul_i32 s68, s71, 12288
s_add_u32 s68, s68, 1048576
s_mov_b32 exec_lo, -1
s_mov_b32 exec_hi, 0xfff
s_mov_b32 s70, 200000
L_poll3:
s_add_u32 s69, s68, 0
buffer_load_dwordx4 v[40:43], v2, s[16:19], s69 offen sc1
s_add_u32 s69, s68, 1024
buffer_load_dwordx4 v[44:47], v2, s[16:19], s69 offen sc1
s_add_u32 s69, s68, 2048
buffer_load_dwordx4 v[48:51], v2, s[16:19], s69 offen sc1
s_add_u32 s69, s68, 3072
buffer_load_dwordx4 v[52:55], v2, s[16:19], s69 offen sc1
s_add_u32 s69, s68, 4096
buffer_load_dwordx4 v[56:59], v2, s[16:19], s69 offen sc1
s_add_u32 s69, s68, 5120
buffer_load_dwordx4 v[60:63], v2, s[16:19], s69 offen sc1
s_add_u32 s69, s68, 6144
buffer_load_dwordx4 v[64:67], v2, s[16:19], s69 offen sc1
s_add_u32 s69, s68, 7168
buffer_load_dwordx4 v[68:71], v2, s[16:19], s69 offen sc1
s_add_u32 s69, s68, 8192
buffer_load_dwordx4 v[72:75], v2, s[16:19], s69 offen sc1
s_add_u32 s69, s68, 9216
buffer_load_dwordx4 v[76:79], v2, s[16:19], s69 offen sc1
s_add_u32 s69, s68, 10240
buffer_load_dwordx4 v[80:83], v2, s[16:19], s69 offen sc1
s_add_u32 s69, s68, 11264
buffer_load_dwordx4 v[84:87], v2, s[16:19], s69 offen sc1
s_waitcnt vmcnt(0)
v_xor_b32 v5, s66, v43
v_xor_b32 v1, s66, v47
v_or_b32 v5, v5, v1
v_xor_b32 v1, s66, v51
v_or_b32 v5, v5, v1
v_xor_b32 v1, s66, v55
v_or_b32 v5, v5, v1
v_xor_b32 v1, s66, v59
v_or_b32 v5, v5, v1
v_xor_b32 v1, s66, v63
v_or_b32 v5, v5, v1
v_xor_b32 v1, s66, v67
v_or_b32 v5, v5, v1
v_xor_b32 v1, s66, v71
v_or_b32 v5, v5, v1
v_xor_b32 v1, s66, v75
v_or_b32 v5, v5, v1
v_xor_b32 v1, s66, v79
v_or_b32 v5, v5, v1
v_xor_b32 v1, s66, v83
v_or_b32 v5, v5, v1
v_xor_b32 v1, s66, v87
v_or_b32 v5, v5, v1
v_cmp_ne_u32 vcc, 0, v5
s_cbranch_vccz L_polld3
s_sub_u32 s70, s70, 1
s_cmp_eq_u32 s70, 0
s_cbranch_scc1 L_polld3
s_sleep 1
s_branch L_poll3
L_polld3:
v_add_f32 v28, v40, v44
v_add_f32 v28, v28, v48
v_add_f32 v28, v28, v52
v_add_f32 v28, v28, v56
v_add_f32 v28, v28, v60
v_add_f32 v28, v28, v64
v_add_f32 v28, v28, v68
v_add_f32 v28, v28, v72
v_add_f32 v28, v28, v76
v_add_f32 v28, v28, v80
v_add_f32 v28, v28, v84
v_add_f32 v29, v41, v45
v_add_f32 v29, v29, v49
v_add_f32 v29, v29, v53
v_add_f32 v29, v29, v57
v_add_f32 v29, v29, v61
v_add_f32 v29, v29, v65
v_add_f32 v29, v29, v69
v_add_f32 v29, v29, v73
v_add_f32 v29, v29, v77
v_add_f32 v29, v29, v81
v_add_f32 v29, v29, v85
v_add_f32 v30, v42, v46
v_add_f32 v30, v30, v50
v_add_f32 v30, v30, v54
v_add_f32 v30, v30, v58
v_add_f32 v30, v30, v62
v_add_f32 v30, v30, v66
v_add_f32 v30, v30, v70
v_add_f32 v30, v30, v74
v_add_f32 v30, v30, v78
v_add_f32 v30, v30, v82
v_add_f32 v30, v30, v86
s_mov_b64 exec, -1
v_add_u32 v3, 22, v0
v_lshlrev_b32 v3, 2, v3
ds_bpermute_b32 v12, v3, v28
ds_bpermute_b32 v13, v3, v29
ds_bpermute_b32 v14, v3, v30
s_lshl_b32 s67, s71, 7
v_mul_u32_u24 v4, 6, v35
v_add_u32 v4, s67, v4
buffer_load_ushort v16, v4, s[8:11], 0 offen offset:0
buffer_load_ushort v17, v4, s[8:11], 0 offen offset:2
buffer_load_ushort v18, v4, s[8:11], 0 offen offset:4
s_waitcnt lgkmcnt(0)
v_add_f32 v8, v28, v12
v_add_f32 v9, v29, v13
v_add_f32 v10, v30, v14
v_cvt_pk_bf16_f32 v8, v8, v8
v_and_b32 v8, 0xffff0000, v8
v_mul_f32 v12, 0xbfb8aa3b, v8
v_exp_f32 v12, v12
s_nop 0
v_add_f32 v12, 1.0, v12
v_rcp_f32 v13, v12
s_nop 0
v_mul_f32 v14, v8, v13
v_cvt_pk_bf16_f32 v28, v14, v14
v_and_b32 v28, 0xffff0000, v28
v_cvt_pk_bf16_f32 v9, v9, v9
v_and_b32 v9, 0xffff0000, v9
v_mul_f32 v12, 0xbfb8aa3b, v9
v_exp_f32 v12, v12
s_nop 0
v_add_f32 v12, 1.0, v12
v_rcp_f32 v13, v12
s_nop 0
v_mul_f32 v14, v9, v13
v_cvt_pk_bf16_f32 v29, v14, v14
v_and_b32 v29, 0xffff0000, v29
v_cvt_pk_bf16_f32 v10, v10, v10
v_and_b32 v10, 0xffff0000, v10
v_mul_f32 v12, 0xbfb8aa3b, v10
v_exp_f32 v12, v12
s_nop 0
v_add_f32 v12, 1.0, v12
v_rcp_f32 v13, v12
s_nop 0
v_mul_f32 v14, v10, v13
v_cvt_pk_bf16_f32 v30, v14, v14
v_and_b32 v30, 0xffff0000, v30
s_waitcnt vmcnt(0)
v_lshlrev_b32 v31, 16, v16
v_lshlrev_b32 v32, 16, v17
v_lshlrev_b32 v33, 16, v18
v_lshlrev_b32 v2, 9, v34
v_lshlrev_b32 v3, 4, v35
v_add_u32 v2, v2, v3
s_lshl_b32 s68, s71, 14
s_add_u32 s68, s68, 851968
s_mov_b32 exec_lo, -1
s_mov_b32 exec_hi, 0xfff
s_mov_b32 s70, 200000
s_add_u32 s69, s68, 0
buffer_load_dwordx4 v[40:43], v2, s[16:19], s69 offen sc1
s_add_u32 s69, s68, 1024
buffer_load_dwordx4 v[44:47], v2, s[16:19], s69 offen sc1
s_add_u32 s69, s68, 2048
buffer_load_dwordx4 v[48:51], v2, s[16:19], s69 offen sc1
s_add_u32 s69, s68, 3072
buffer_load_dwordx4 v[52:55], v2, s[16:19], s69 offen sc1
s_add_u32 s69, s68, 4096
buffer_load_dwordx4 v[56:59], v2, s[16:19], s69 offen sc1
s_add_u32 s69, s68, 5120
buffer_load_dwordx4 v[60:63], v2, s[16:19], s69 offen sc1
s_add_u32 s69, s68, 6144
buffer_load_dwordx4 v[64:67], v2, s[16:19], s69 offen sc1
s_add_u32 s69, s68, 7168
buffer_load_dwordx4 v[68:71], v2, s[16:19], s69 offen sc1
s_add_u32 s69, s68, 8192
buffer_load_dwordx4 v[72:75], v2, s[16:19], s69 offen sc1
s_add_u32 s69, s68, 9216
buffer_load_dwordx4 v[76:79], v2, s[16:19], s69 offen sc1
s_add_u32 s69, s68, 10240
buffer_load_dwordx4 v[80:83], v2, s[16:19], s69 offen sc1
s_add_u32 s69, s68, 11264
buffer_load_dwordx4 v[84:87], v2, s[16:19], s69 offen sc1
s_add_u32 s69, s68, 12288
buffer_load_dwordx4 v[88:91], v2, s[16:19], s69 offen sc1
s_add_u32 s69, s68, 13312
buffer_load_dwordx4 v[92:95], v2, s[16:19], s69 offen sc1
s_add_u32 s69, s68, 14336
buffer_load_dwordx4 v[96:99], v2, s[16:19], s69 offen sc1
s_add_u32 s69, s68, 15360
buffer_load_dwordx4 v[100:103], v2, s[16:19], s69 offen sc1
L_poll4:
s_sleep 2
s_add_u32 s69, s68, 0
buffer_load_dwordx4 v[104:107], v2, s[16:19], s69 offen sc1
s_add_u32 s69, s68, 1024
buffer_load_dwordx4 v[108:111], v2, s[16:19], s69 offen sc1
s_add_u32 s69, s68, 2048
buffer_load_dwordx4 v[112:115], v2, s[16:19], s69 offen sc1
s_add_u32 s69, s68, 3072
buffer_load_dwordx4 v[116:119], v2, s[16:19], s69 offen sc1
s_add_u32 s69, s68, 4096
buffer_load_dwordx4 v[120:123], v2, s[16:19], s69 offen sc1
s_add_u32 s69, s68, 5120
buffer_load_dwordx4 v[124:127], v2, s[16:19], s69 offen sc1
s_add_u32 s69, s68, 6144
buffer_load_dwordx4 v[128:131], v2, s[16:19], s69 offen sc1
s_add_u32 s69, s68, 7168
buffer_load_dwordx4 v[132:135], v2, s[16:19], s69 offen sc1
s_add_u32 s69, s68, 8192
buffer_load_dwordx4 v[136:139], v2, s[16:19], s69 offen sc1
s_add_u32 s69, s68, 9216
buffer_load_dwordx4 v[140:143], v2, s[16:19], s69 offen sc1
s_add_u32 s69, s68, 10240
buffer_load_dwordx4 v[144:147], v2, s[16:19], s69 offen sc1
s_add_u32 s69, s68, 11264
buffer_load_dwordx4 v[148:151], v2, s[16:19], s69 offen sc1
s_add_u32 s69, s68, 12288
buffer_load_dwordx4 v[152:155], v2, s[16:19], s69 offen sc1
s_add_u32 s69, s68, 13312
buffer_load_dwordx4 v[156:159], v2, s[16:19], s69 offen sc1
s_add_u32 s69, s68, 14336
buffer_load_dwordx4 v[160:163], v2, s[16:19], s69 offen sc1
s_add_u32 s69, s68, 15360
buffer_load_dwordx4 v[164:167], v2, s[16:19], s69 offen sc1
s_waitcnt vmcnt(16)
v_xor_b32 v5, s66, v43
v_xor_b32 v1, s66, v47
v_or_b32 v5, v5, v1
v_xor_b32 v1, s66, v51
v_or_b32 v5, v5, v1
v_xor_b32 v1, s66, v55
v_or_b32 v5, v5, v1
v_xor_b32 v1, s66, v59
v_or_b32 v5, v5, v1
v_xor_b32 v1, s66, v63
v_or_b32 v5, v5, v1
v_xor_b32 v1, s66, v67
v_or_b32 v5, v5, v1
v_xor_b32 v1, s66, v71
v_or_b32 v5, v5, v1
v_xor_b32 v1, s66, v75
v_or_b32 v5, v5, v1
v_xor_b32 v1, s66, v79
v_or_b32 v5, v5, v1
v_xor_b32 v1, s66, v83
v_or_b32 v5, v5, v1
v_xor_b32 v1, s66, v87
v_or_b32 v5, v5, v1
v_xor_b32 v1, s66, v91
v_or_b32 v5, v5, v1
v_xor_b32 v1, s66, v95
v_or_b32 v5, v5, v1
v_xor_b32 v1, s66, v99
v_or_b32 v5, v5, v1
v_xor_b32 v1, s66, v103
v_or_b32 v5, v5, v1
v_cmp_ne_u32 vcc, 0, v5
s_cbranch_vccz L_pollA4
s_sub_u32 s70, s70, 1
s_cmp_eq_u32 s70, 0
s_cbranch_scc1 L_pollA4
s_sleep 2
s_add_u32 s69, s68, 0
buffer_load_dwordx4 v[40:43], v2, s[16:19], s69 offen sc1
s_add_u32 s69, s68, 1024
buffer_load_dwordx4 v[44:47], v2, s[16:19], s69 offen sc1
s_add_u32 s69, s68, 2048
buffer_load_dwordx4 v[48:51], v2, s[16:19], s69 offen sc1
s_add_u32 s69, s68, 3072
buffer_load_dwordx4 v[52:55], v2, s[16:19], s69 offen sc1
s_add_u32 s69, s68, 4096
buffer_load_dwordx4 v[56:59], v2, s[16:19], s69 offen sc1
s_add_u32 s69, s68, 5120
buffer_load_dwordx4 v[60:63], v2, s[16:19], s69 offen sc1
s_add_u32 s69, s68, 6144
buffer_load_dwordx4 v[64:67], v2, s[16:19], s69 offen sc1
s_add_u32 s69, s68, 7168
buffer_load_dwordx4 v[68:71], v2, s[16:19], s69 offen sc1
s_add_u32 s69, s68, 8192
buffer_load_dwordx4 v[72:75], v2, s[16:19], s69 offen sc1
s_add_u32 s69, s68, 9216
buffer_load_dwordx4 v[76:79], v2, s[16:19], s69 offen sc1
s_add_u32 s69, s68, 10240
buffer_load_dwordx4 v[80:83], v2, s[16:19], s69 offen sc1
s_add_u32 s69, s68, 11264
buffer_load_dwordx4 v[84:87], v2, s[16:19], s69 offen sc1
s_add_u32 s69, s68, 12288
buffer_load_dwordx4 v[88:91], v2, s[16:19], s69 offen sc1
s_add_u32 s69, s68, 13312
buffer_load_dwordx4 v[92:95], v2, s[16:19], s69 offen sc1
s_add_u32 s69, s68, 14336
buffer_load_dwordx4 v[96:99], v2, s[16:19], s69 offen sc1
s_add_u32 s69, s68, 15360
buffer_load_dwordx4 v[100:103], v2, s[16:19], s69 offen sc1
s_waitcnt vmcnt(16)
v_xor_b32 v5, s66, v107
v_xor_b32 v1, s66, v111
v_or_b32 v5, v5, v1
v_xor_b32 v1, s66, v115
v_or_b32 v5, v5, v1
v_xor_b32 v1, s66, v119
v_or_b32 v5, v5, v1
v_xor_b32 v1, s66, v123
v_or_b32 v5, v5, v1
v_xor_b32 v1, s66, v127
v_or_b32 v5, v5, v1
v_xor_b32 v1, s66, v131
v_or_b32 v5, v5, v1
v_xor_b32 v1, s66, v135
v_or_b32 v5, v5, v1
v_xor_b32 v1, s66, v139
v_or_b32 v5, v5, v1
v_xor_b32 v1, s66, v143
v_or_b32 v5, v5, v1
v_xor_b32 v1, s66, v147
v_or_b32 v5, v5, v1
v_xor_b32 v1, s66, v151
v_or_b32 v5, v5, v1
v_xor_b32 v1, s66, v155
v_or_b32 v5, v5, v1
v_xor_b32 v1, s66, v159
v_or_b32 v5, v5, v1
v_xor_b32 v1, s66, v163
v_or_b32 v5, v5, v1
v_xor_b32 v1, s66, v167
v_or_b32 v5, v5, v1
v_cmp_ne_u32 vcc, 0, v5
s_cbranch_vccz L_pollB4
s_sub_u32 s70, s70, 1
s_cmp_eq_u32 s70, 0
s_cbranch_scc1 L_pollB4
s_branch L_poll4
L_pollB4:
v_add_f32 v8, v104, v108
v_add_f32 v9, v105, v109
v_add_f32 v10, v106, v110
v_add_f32 v8, v8, v112
v_add_f32 v9, v9, v113
v_add_f32 v10, v10, v114
v_add_f32 v8, v8, v116
v_add_f32 v9, v9, v117
v_add_f32 v10, v10, v118
v_add_f32 v8, v8, v120
v_add_f32 v9, v9, v121
v_add_f32 v10, v10, v122
v_add_f32 v8, v8, v124
v_add_f32 v9, v9, v125
v_add_f32 v10, v10, v126
v_add_f32 v8, v8, v128
v_add_f32 v9, v9, v129
v_add_f32 v10, v10, v130
v_add_f32 v8, v8, v132
v_add_f32 v9, v9, v133
v_add_f32 v10, v10, v134
v_add_f32 v8, v8, v136
v_add_f32 v9, v9, v137
v_add_f32 v10, v10, v138
v_add_f32 v8, v8, v140
v_add_f32 v9, v9, v141
v_add_f32 v10, v10, v142
v_add_f32 v8, v8, v144
v_add_f32 v9, v9, v145
v_add_f32 v10, v10, v146
v_add_f32 v8, v8, v148
v_add_f32 v9, v9, v149
v_add_f32 v10, v10, v150
v_add_f32 v8, v8, v152
v_add_f32 v9, v9, v153
v_add_f32 v10, v10, v154
v_add_f32 v8, v8, v156
v_add_f32 v9, v9, v157
v_add_f32 v10, v10, v158
v_add_f32 v8, v8, v160
v_add_f32 v9, v9, v161
v_add_f32 v10, v10, v162
v_add_f32 v8, v8, v164
v_add_f32 v9, v9, v165
v_add_f32 v10, v10, v166
s_branch L_polld4
L_pollA4:
v_add_f32 v8, v40, v44
v_add_f32 v9, v41, v45
v_add_f32 v10, v42, v46
v_add_f32 v8, v8, v48
v_add_f32 v9, v9, v49
v_add_f32 v10, v10, v50
v_add_f32 v8, v8, v52
v_add_f32 v9, v9, v53
v_add_f32 v10, v10, v54
v_add_f32 v8, v8, v56
v_add_f32 v9, v9, v57
v_add_f32 v10, v10, v58
v_add_f32 v8, v8, v60
v_add_f32 v9, v9, v61
v_add_f32 v10, v10, v62
v_add_f32 v8, v8, v64
v_add_f32 v9, v9, v65
v_add_f32 v10, v10, v66
v_add_f32 v8, v8, v68
v_add_f32 v9, v9, v69
v_add_f32 v10, v10, v70
v_add_f32 v8, v8, v72
v_add_f32 v9, v9, v73
v_add_f32 v10, v10, v74
v_add_f32 v8, v8, v76
v_add_f32 v9, v9, v77
v_add_f32 v10, v10, v78
v_add_f32 v8, v8, v80
v_add_f32 v9, v9, v81
v_add_f32 v10, v10, v82
v_add_f32 v8, v8, v84
v_add_f32 v9, v9, v85
v_add_f32 v10, v10, v86
v_add_f32 v8, v8, v88
v_add_f32 v9, v9, v89
v_add_f32 v10, v10, v90
v_add_f32 v8, v8, v92
v_add_f32 v9, v9, v93
v_add_f32 v10, v10, v94
v_add_f32 v8, v8, v96
v_add_f32 v9, v9, v97
v_add_f32 v10, v10, v98
v_add_f32 v8, v8, v100
v_add_f32 v9, v9, v101
v_add_f32 v10, v10, v102
L_polld4:
s_mov_b64 exec, -1
v_add_u32 v3, 22, v0
v_lshlrev_b32 v3, 2, v3
ds_bpermute_b32 v12, v3, v8
ds_bpermute_b32 v13, v3, v9
ds_bpermute_b32 v14, v3, v10
s_waitcnt lgkmcnt(0)
v_add_f32 v8, v8, v12
v_cvt_pk_bf16_f32 v8, v8, v8
v_and_b32 v8, 0xffff0000, v8
v_mul_f32 v8, v8, v28
v_cvt_pk_bf16_f32 v8, v8, v8
v_and_b32 v8, 0xffff0000, v8
v_add_f32 v8, v8, v31
v_cvt_pk_bf16_f32 v8, v8, v8
v_add_f32 v9, v9, v13
v_cvt_pk_bf16_f32 v9, v9, v9
v_and_b32 v9, 0xffff0000, v9
v_mul_f32 v9, v9, v29
v_cvt_pk_bf16_f32 v9, v9, v9
v_and_b32 v9, 0xffff0000, v9
v_add_f32 v9, v9, v32
v_cvt_pk_bf16_f32 v9, v9, v9
v_add_f32 v10, v10, v14
v_cvt_pk_bf16_f32 v10, v10, v10
v_and_b32 v10, 0xffff0000, v10
v_mul_f32 v10, v10, v30
v_cvt_pk_bf16_f32 v10, v10, v10
v_and_b32 v10, 0xffff0000, v10
v_add_f32 v10, v10, v33
v_cvt_pk_bf16_f32 v10, v10, v10
s_lshl_b32 s67, s71, 7
v_mul_u32_u24 v4, 6, v35
v_add_u32 v4, s67, v4
s_mov_b32 exec_lo, 0x003fffff
s_mov_b32 exec_hi, 0
buffer_store_short v8, v4, s[36:39], 0 offen
s_mov_b32 exec_lo, 0x001fffff
buffer_store_short v9, v4, s[36:39], 0 offen offset:2
buffer_store_short v10, v4, s[36:39], 0 offen offset:4
s_cmp_lg_u32 s71, 0
s_cbranch_scc1 L_fin
s_mov_b64 exec, 1
v_mov_b32 v5, 0
v_mov_b32 v1, s66
buffer_store_dword v1, v5, s[16:19], 0 offen sc1
L_fin:
L_exit:
s_endpgm
.section .rodata,"a"
.p2align 6
.amdhsa_kernel recurrent_scan__mha_block_cached__glu_gated_reglu__decode_kernel
  .amdhsa_next_free_vgpr 512
  .amdhsa_next_free_sgpr 96
  .amdhsa_accum_offset 256
  .amdhsa_group_segment_fixed_size 0
  .amdhsa_kernarg_size 96
  .amdhsa_user_sgpr_count 2
  .amdhsa_user_sgpr_kernarg_segment_ptr 1
  .amdhsa_system_sgpr_workgroup_id_x 1
  .amdhsa_float_denorm_mode_32 3
.end_amdhsa_kernel
```
